```python
import torch

def _softmax(x, axis=-1):
    return torch.softmax(x, dim=axis)

def _gelu(x):
    return torch.nn.functional.gelu(x, approximate='tanh')

def _silu(x):
    return torch.nn.functional.silu(x)

def _sigmoid(x):
    return torch.sigmoid(x)

def _layernorm(x, axis=-1, eps=1e-05):
    m = x.mean(dim=axis, keepdim=True)
    v = x.var(dim=axis, keepdim=True, unbiased=False)
    return (x - m) / torch.sqrt(v + eps)

def _scatter_add(tgt, idx, src, axis=0):
    return tgt.clone().index_add_(axis, idx, src)

def _segment_sum(src, seg, n):
    out = torch.zeros((n,) + src.shape[1:], dtype=src.dtype)
    return out.index_add_(0, seg, src)

def _pad(x, pw):
    flat = tuple((v for pair in reversed(pw) for v in pair))
    return torch.nn.functional.pad(x, flat)
kernel_name = 'adaLN_cond__gqa_block_cached__glu_gated_geglu__decode'

def setup_inputs():

    _w = lambda a: (lambda t: t.to(torch.bfloat16) if t.is_floating_point() else t)(torch.as_tensor(a))

    def _A_setup():
        B, Sq, D = (4, 1, 512)
        Hq, Hkv, Sk, Dh = (32, 32, 4096, 128)
        assert Hq % Hkv == 0, (Hq, Hkv)
        return {'x': _w((lambda *s: torch.randn(*s, dtype=torch.bfloat16) * 0.1)(B, Sq, D)), 'k_cache': _w((lambda *s: torch.randn(*s, dtype=torch.bfloat16) * 0.8)(B, Hkv, Sk, Dh)), 'v_cache': _w((lambda *s: torch.randn(*s, dtype=torch.bfloat16) * 3.2)(B, Hkv, Sk, Dh)), 'wq': _w((lambda *s: torch.randn(*s, dtype=torch.bfloat16) * 0.8)(D, Hq * Dh) * D ** (-0.5)), 'wo': _w((lambda *s: torch.randn(*s, dtype=torch.bfloat16) * 3.2)(Hq * Dh, D) * (Hq * Dh) ** (-0.5))}
    _A_in = _A_setup()

    def _B_setup():
        B, S, Dm, Df = (4, 1, 512, 1376)
        return {'x': _w((lambda *s: torch.randn(*s, dtype=torch.bfloat16) * 0.1)(B, S, Dm)), 'w_gate': _w((lambda *s: torch.randn(*s, dtype=torch.bfloat16) * 3.2)(Dm, Df) * Dm ** (-0.5)), 'w_up': _w((lambda *s: torch.randn(*s, dtype=torch.bfloat16) * 3.2)(Dm, Df) * Dm ** (-0.5)), 'w_down': _w((lambda *s: torch.randn(*s, dtype=torch.bfloat16) * 3.2)(Df, Dm) * Df ** (-0.5))}
    _B_in = _B_setup()
    return {'A_x': _A_in['x'], 'A_k_cache': _A_in['k_cache'], 'A_v_cache': _A_in['v_cache'], 'A_wq': _A_in['wq'], 'A_wo': _A_in['wo'], 'B_x': _B_in['x'], 'B_w_gate': _B_in['w_gate'], 'B_w_up': _B_in['w_up'], 'B_w_down': _B_in['w_down'], 'c': _w((lambda *s: torch.randn(*s, dtype=torch.bfloat16) * 0.4)(4, 512) * 8.0), 'w_mod': _w((lambda *s: torch.randn(*s, dtype=torch.bfloat16) * 0.4)(512, 6 * 512) * 512 ** (-0.5) * 8.0)}

def reference(A_x, A_k_cache, A_v_cache, A_wq, A_wo, B_x, B_w_gate, B_w_up, B_w_down, c, w_mod):

    def _A_ref(x, k_cache, v_cache, wq, wo):
        B, Sq, D = x.shape
        Hq, Dh = (32, 128)
        Hkv = k_cache.shape[1]
        rep = Hq // Hkv
        q = (lambda x, *d: x.permute(*d))((x @ wq).reshape(B, Sq, Hq, Dh), 0, 2, 1, 3)
        k = (lambda x, n, axis: torch.repeat_interleave(x, n, dim=axis))(k_cache, rep, axis=1)
        v = (lambda x, n, axis: torch.repeat_interleave(x, n, dim=axis))(v_cache, rep, axis=1)
        scores = torch.einsum('bhqd,bhkd->bhqk', q, k) * Dh ** (-0.5)
        p = _softmax(scores, axis=-1)
        o = torch.einsum('bhqk,bhkd->bhqd', p, v)
        return (lambda x, *d: x.permute(*d))(o, 0, 2, 1, 3).reshape(B, Sq, Hq * Dh) @ wo

    def _B_ref(x, w_gate, w_up, w_down):
        g = torch.einsum('bsd,df->bsf', x, w_gate)
        u = torch.einsum('bsd,df->bsf', x, w_up)
        h = _gelu(g) * u
        return torch.einsum('bsf,fd->bsd', h, w_down)
    x = A_x
    mod = (_silu(c) @ w_mod).reshape(c.shape[0], 6, 1, -1)
    sa, ca, ga, sb, cb, gb = (mod[:, 0].clone(), mod[:, 1].clone(), mod[:, 2].clone(), mod[:, 3].clone(), mod[:, 4].clone(), mod[:, 5].clone())
    h = _layernorm(x, axis=-1) * (1 + ca) + sa
    x = x + ga * _A_ref(h, A_k_cache, A_v_cache, A_wq, A_wo)
    h = _layernorm(x, axis=-1) * (1 + cb) + sb
    x = x + gb * _B_ref(h, B_w_gate, B_w_up, B_w_down)
    return x
```

```asm
; @launch grid=(256,1,1) block=(512,1,1) lds=163840
.amdgcn_target "amdgcn-amd-amdhsa--gfx950"
.text
.globl adaLN_cond__gqa_block_cached__glu_gated_geglu__decode_kernel
.p2align 8
.type adaLN_cond__gqa_block_cached__glu_gated_geglu__decode_kernel,@function
adaLN_cond__gqa_block_cached__glu_gated_geglu__decode_kernel:
L_entry:
    s_cmp_ge_u32 s2, 256
    s_cbranch_scc1 L_exit
    s_load_dwordx16 s[16:31], s[0:1], 0
    s_load_dwordx8 s[32:39], s[0:1], 64
    s_load_dwordx4 s[40:43], s[0:1], 96
    s_and_b32 s10, s2, 0x38
    s_cmp_lg_u32 s10, 0
    s_cbranch_scc1 L_nowarm0
    s_getpc_b64 s[10:11]
L_pc0:
    s_sub_u32 s10, s10, L_pc0-L_entry
    s_subb_u32 s11, s11, 0
    v_lshlrev_b32 v1, 7, v0
    v_cmp_gt_u32 vcc, L_exit-L_entry, v1
    s_nop 0
    s_and_saveexec_b64 s[12:13], vcc
    s_cbranch_execz L_nowarm0x
    global_load_dword v255, v1, s[10:11]
L_nowarm0x:
    s_mov_b64 exec, s[12:13]
L_nowarm0:
    v_lshrrev_b32 v1, 6, v0
    v_and_b32 v0, 63, v0
    v_readfirstlane_b32 s3, v1
    s_and_b32 s8, s2, 7
    s_lshr_b32 s9, s2, 3
    s_bfe_u32 s5, s9, 0x20001
    s_and_b32 s6, s9, 1
    s_mul_i32 s10, s6, 5
    s_xor_b32 s10, s10, s8
    s_lshr_b32 s11, s9, 3
    s_lshl_b32 s4, s10, 2
    s_add_u32 s4, s4, s11
    s_lshr_b32 s100, s2, 4
    s_lshl_b32 s100, s100, 3
    s_add_u32 s100, s100, s10
    s_mul_i32 s11, s11, 3
    s_add_u32 s11, s11, s5
    s_sub_u32 s11, s11, 1
    s_lshl_b32 s12, s11, 2
    s_add_u32 s12, s12, s8
    s_add_u32 s13, s12, 12
    s_cmp_lt_u32 s8, 4
    s_cselect_b32 s12, s12, s13
    s_lshl_b32 s99, s11, 3
    s_add_u32 s99, s99, s8
    s_cmp_lt_u32 s11, 4
    s_cselect_b32 s99, s12, s99
    s_cmp_eq_u32 s5, 0
    s_cselect_b32 s99, 127, s99
    s_cmp_eq_u32 s6, 0
    s_cselect_b32 s99, 126, s99
    s_mul_i32 s101, s8, 6
    s_add_u32 s101, s101, s11
    s_sub_u32 s101, s101, 6
    s_sub_u32 s12, s99, 48
    s_cmp_lt_u32 s12, 48
    s_cselect_b32 s101, s101, 64
    v_lshrrev_b32 v30, 4, v0
    v_and_b32 v31, 15, v0
    s_cmp_ge_u32 s3, 4
    s_cbranch_scc1 L_service
    s_setprio 1
    v_lshrrev_b32 v3, 2, v31
    v_and_b32 v4, 3, v31
    v_lshlrev_b32 v1, 8, v3
    v_lshl_add_u32 v1, v4, 4, v1
    v_lshl_add_u32 v1, v30, 6, v1
    v_lshlrev_b32 v2, 4, v0
    s_lshl_b32 s57, s5, 5
    s_add_u32 s57, s57, s4
    s_lshl_b32 s57, s57, 20
    s_lshl_b32 s10, s6, 19
    s_add_u32 s57, s57, s10
    s_lshl_b32 s10, s3, 12
    s_add_u32 s57, s57, s10
    s_mov_b32 s58, s57
    s_xor_b32 s98, s57, 0x80000
    v_mov_b32 v8, 0
    v_mov_b32 v9, 0
    v_mov_b32 v10, 0
    v_mov_b32 v11, 0
    v_mov_b32 v12, -1
    v_mov_b32 v13, -1
    v_mov_b32 v14, -1
    v_mov_b32 v15, -1
    ds_write_b128 v8, v[8:11] offset:0
    ds_write_b128 v8, v[8:11] offset:16
    ds_write_b128 v8, v[12:15] offset:32
    s_waitcnt lgkmcnt(0)
    s_mov_b32 s44, s18
    s_mov_b32 s45, s19
    s_mov_b32 s46, 134217728
    s_mov_b32 s47, 0x20000
    s_mov_b32 s48, s20
    s_mov_b32 s49, s21
    s_mov_b32 s50, 134217728
    s_mov_b32 s51, 0x20000
    buffer_load_dwordx4 v[64:67], v1, s[44:47], s57 offen nt
    buffer_load_dwordx4 v[68:71], v1, s[44:47], s57 offen offset:1024 nt
    buffer_load_dwordx4 v[72:75], v1, s[44:47], s57 offen offset:2048 nt
    buffer_load_dwordx4 v[76:79], v1, s[44:47], s57 offen offset:3072 nt
    s_add_u32 s57, s57, 16384
    buffer_load_dwordx4 v[80:83], v1, s[44:47], s57 offen nt
    buffer_load_dwordx4 v[84:87], v1, s[44:47], s57 offen offset:1024 nt
    buffer_load_dwordx4 v[88:91], v1, s[44:47], s57 offen offset:2048 nt
    buffer_load_dwordx4 v[92:95], v1, s[44:47], s57 offen offset:3072 nt
    s_add_u32 s57, s57, 16384
    s_barrier
    s_load_dword s56, s[42:43], 0
    s_mov_b32 s60, 0xf000f
    s_mov_b32 s61, 0xf000f
    s_mov_b32 s62, 0xf000f0
    s_mov_b32 s63, 0xf000f0
    s_mov_b32 s64, 0xf000f00
    s_mov_b32 s65, 0xf000f00
    s_mov_b32 s66, 0xf000f000
    s_mov_b32 s67, 0xf000f000
    s_mov_b32 s68, 0xaaaaaaaa
    s_mov_b32 s69, 0xaaaaaaaa
    s_mov_b32 s70, 0xcccccccc
    s_mov_b32 s71, 0xcccccccc
    s_mul_i32 s14, s3, 32768
    s_add_u32 s14, s14, 32768
    v_add_u32 v59, s14, v2
    v_lshlrev_b32 v58, 5, v4
    v_lshl_add_u32 v58, v30, 7, v58
    s_mov_b32 s52, s42
    s_mov_b32 s53, s43
    s_mov_b32 s54, 2097152
    s_mov_b32 s55, 0x20000
    s_lshl_b32 s59, s4, 2
    s_add_u32 s59, s59, s5
    s_lshl_b32 s59, s59, 9
    s_add_u32 s59, s59, 196608
    s_mul_i32 s10, s3, 2688
    s_add_u32 s10, s10, 128
    v_lshlrev_b32 v28, 6, v4
    v_lshl_add_u32 v28, v30, 4, v28
    v_lshl_add_u32 v28, v3, 2, v28
    v_add_u32 v56, s10, v28
    v_lshl_add_u32 v3, v30, 4, s10
    v_and_b32 v8, 1, v31
    v_cmp_eq_u32 vcc, 1, v8
    v_mov_b32 v9, 0xffff
    v_mov_b32 v10, 0xffff0000
    v_cndmask_b32 v9, v9, v10, vcc
    v_bfe_u32 v8, v31, 1, 2
    v_cmp_eq_u32 vcc, 0, v8
    s_nop 1
    v_cndmask_b32 v4, 0, v9, vcc
    v_cmp_eq_u32 vcc, 1, v8
    s_nop 1
    v_cndmask_b32 v5, 0, v9, vcc
    v_cmp_eq_u32 vcc, 2, v8
    s_nop 1
    v_cndmask_b32 v6, 0, v9, vcc
    v_cmp_eq_u32 vcc, 3, v8
    s_nop 1
    v_cndmask_b32 v7, 0, v9, vcc
    v_mov_b32 v57, 0xff800000
    s_cmp_eq_u32 s99, 255
    s_cbranch_scc1 L_pause
    s_cmp_ge_u32 s99, 16
    s_cbranch_scc1 L_pauseok
L_pause:
    v_mov_b32 v16, 0
    s_mov_b32 s15, 131072
L_pausew:
    ds_read_b32 v17, v16 offset:20
    s_waitcnt lgkmcnt(0)
    v_cmp_eq_u32 vcc, 4, v17
    s_cbranch_vccnz L_pauseok
    s_sleep 1
    s_sub_u32 s15, s15, 1
    s_cmp_lg_u32 s15, 0
    s_cbranch_scc1 L_pausew
L_pauseok:
    s_waitcnt vmcnt(7)
    buffer_load_dwordx4 v[96:99], v1, s[44:47], s57 offen nt
    s_waitcnt vmcnt(7)
    buffer_load_dwordx4 v[100:103], v1, s[44:47], s57 offen offset:1024 nt
    s_waitcnt vmcnt(7)
    buffer_load_dwordx4 v[104:107], v1, s[44:47], s57 offen offset:2048 nt
    s_waitcnt vmcnt(7)
    buffer_load_dwordx4 v[108:111], v1, s[44:47], s57 offen offset:3072 nt
    s_add_u32 s57, s57, 16384
    s_waitcnt vmcnt(7)
    buffer_load_dwordx4 v[112:115], v1, s[44:47], s57 offen nt
    s_waitcnt vmcnt(7)
    buffer_load_dwordx4 v[116:119], v1, s[44:47], s57 offen offset:1024 nt
    s_waitcnt vmcnt(7)
    buffer_load_dwordx4 v[120:123], v1, s[44:47], s57 offen offset:2048 nt
    s_waitcnt vmcnt(7)
    buffer_load_dwordx4 v[124:127], v1, s[44:47], s57 offen offset:3072 nt
    s_add_u32 s57, s57, 16384
    s_waitcnt vmcnt(7)
    buffer_load_dwordx4 v[128:131], v1, s[44:47], s57 offen nt
    s_waitcnt vmcnt(7)
    buffer_load_dwordx4 v[132:135], v1, s[44:47], s57 offen offset:1024 nt
    s_waitcnt vmcnt(7)
    buffer_load_dwordx4 v[136:139], v1, s[44:47], s57 offen offset:2048 nt
    s_waitcnt vmcnt(7)
    buffer_load_dwordx4 v[140:143], v1, s[44:47], s57 offen offset:3072 nt
    s_add_u32 s57, s57, 16384
    s_waitcnt vmcnt(7)
    buffer_load_dwordx4 v[144:147], v1, s[44:47], s57 offen nt
    s_waitcnt vmcnt(7)
    buffer_load_dwordx4 v[148:151], v1, s[44:47], s57 offen offset:1024 nt
    s_waitcnt vmcnt(7)
    buffer_load_dwordx4 v[152:155], v1, s[44:47], s57 offen offset:2048 nt
    s_waitcnt vmcnt(7)
    buffer_load_dwordx4 v[156:159], v1, s[44:47], s57 offen offset:3072 nt
    s_add_u32 s57, s57, 16384
    s_waitcnt vmcnt(7)
    buffer_load_dwordx4 v[160:163], v1, s[44:47], s57 offen nt
    s_waitcnt vmcnt(7)
    buffer_load_dwordx4 v[164:167], v1, s[44:47], s57 offen offset:1024 nt
    s_waitcnt vmcnt(7)
    buffer_load_dwordx4 v[168:171], v1, s[44:47], s57 offen offset:2048 nt
    s_waitcnt vmcnt(7)
    buffer_load_dwordx4 v[172:175], v1, s[44:47], s57 offen offset:3072 nt
    s_add_u32 s57, s57, 16384
    s_waitcnt vmcnt(7)
    buffer_load_dwordx4 v[176:179], v1, s[44:47], s57 offen nt
    s_waitcnt vmcnt(7)
    buffer_load_dwordx4 v[180:183], v1, s[44:47], s57 offen offset:1024 nt
    s_waitcnt vmcnt(7)
    buffer_load_dwordx4 v[184:187], v1, s[44:47], s57 offen offset:2048 nt
    s_waitcnt vmcnt(7)
    buffer_load_dwordx4 v[188:191], v1, s[44:47], s57 offen offset:3072 nt
    s_add_u32 s57, s57, 16384
    s_waitcnt vmcnt(7)
    buffer_load_dwordx4 v[192:195], v1, s[44:47], s57 offen nt
    s_waitcnt vmcnt(7)
    buffer_load_dwordx4 v[196:199], v1, s[44:47], s57 offen offset:1024 nt
    s_waitcnt vmcnt(7)
    buffer_load_dwordx4 v[200:203], v1, s[44:47], s57 offen offset:2048 nt
    s_waitcnt vmcnt(7)
    buffer_load_dwordx4 v[204:207], v1, s[44:47], s57 offen offset:3072 nt
    s_add_u32 s57, s57, 16384
    s_waitcnt vmcnt(7)
    buffer_load_dwordx4 v[208:211], v1, s[44:47], s57 offen nt
    s_waitcnt vmcnt(7)
    buffer_load_dwordx4 v[212:215], v1, s[44:47], s57 offen offset:1024 nt
    s_waitcnt vmcnt(7)
    buffer_load_dwordx4 v[216:219], v1, s[44:47], s57 offen offset:2048 nt
    s_waitcnt vmcnt(7)
    buffer_load_dwordx4 v[220:223], v1, s[44:47], s57 offen offset:3072 nt
    s_add_u32 s57, s57, 16384
    s_waitcnt vmcnt(7)
    buffer_load_dwordx4 v[224:227], v1, s[44:47], s57 offen nt
    s_waitcnt vmcnt(7)
    buffer_load_dwordx4 v[228:231], v1, s[44:47], s57 offen offset:1024 nt
    s_waitcnt vmcnt(7)
    buffer_load_dwordx4 v[232:235], v1, s[44:47], s57 offen offset:2048 nt
    s_waitcnt vmcnt(7)
    buffer_load_dwordx4 v[236:239], v1, s[44:47], s57 offen offset:3072 nt
    s_add_u32 s57, s57, 16384
    s_waitcnt vmcnt(7)
    s_add_u32 m0, s14, 0
    s_nop 0
    buffer_load_dwordx4 v1, s[44:47], s57 offen nt lds
    s_waitcnt vmcnt(7)
    buffer_load_dwordx4 v1, s[44:47], s57 offen offset:1024 nt lds
    s_waitcnt vmcnt(7)
    buffer_load_dwordx4 v1, s[44:47], s57 offen offset:2048 nt lds
    s_waitcnt vmcnt(7)
    buffer_load_dwordx4 v1, s[44:47], s57 offen offset:3072 nt lds
    s_add_u32 s57, s57, 16384
    s_waitcnt vmcnt(7)
    s_add_u32 m0, s14, 4096
    s_nop 0
    buffer_load_dwordx4 v1, s[44:47], s57 offen nt lds
    s_waitcnt vmcnt(7)
    buffer_load_dwordx4 v1, s[44:47], s57 offen offset:1024 nt lds
    s_waitcnt vmcnt(7)
    buffer_load_dwordx4 v1, s[44:47], s57 offen offset:2048 nt lds
    s_waitcnt vmcnt(7)
    buffer_load_dwordx4 v1, s[44:47], s57 offen offset:3072 nt lds
    s_add_u32 s57, s57, 16384
    s_waitcnt vmcnt(7)
    s_add_u32 m0, s14, 8192
    s_nop 0
    buffer_load_dwordx4 v1, s[44:47], s57 offen nt lds
    s_waitcnt vmcnt(7)
    buffer_load_dwordx4 v1, s[44:47], s57 offen offset:1024 nt lds
    s_waitcnt vmcnt(7)
    buffer_load_dwordx4 v1, s[44:47], s57 offen offset:2048 nt lds
    s_waitcnt vmcnt(7)
    buffer_load_dwordx4 v1, s[44:47], s57 offen offset:3072 nt lds
    s_add_u32 s57, s57, 16384
    s_waitcnt vmcnt(7)
    s_add_u32 m0, s14, 12288
    s_nop 0
    buffer_load_dwordx4 v1, s[44:47], s57 offen nt lds
    s_waitcnt vmcnt(7)
    buffer_load_dwordx4 v1, s[44:47], s57 offen offset:1024 nt lds
    s_waitcnt vmcnt(7)
    buffer_load_dwordx4 v1, s[44:47], s57 offen offset:2048 nt lds
    s_waitcnt vmcnt(7)
    buffer_load_dwordx4 v1, s[44:47], s57 offen offset:3072 nt lds
    s_add_u32 s57, s57, 16384
    s_waitcnt vmcnt(7)
    s_add_u32 m0, s14, 16384
    s_nop 0
    buffer_load_dwordx4 v1, s[44:47], s57 offen nt lds
    s_waitcnt vmcnt(7)
    buffer_load_dwordx4 v1, s[44:47], s57 offen offset:1024 nt lds
    s_waitcnt vmcnt(7)
    buffer_load_dwordx4 v1, s[44:47], s57 offen offset:2048 nt lds
    s_waitcnt vmcnt(7)
    buffer_load_dwordx4 v1, s[44:47], s57 offen offset:3072 nt lds
    s_add_u32 s57, s57, 16384
    buffer_load_dwordx4 v[8:11], v58, s[52:55], s59 offen sc1
    buffer_load_dwordx4 v[12:15], v58, s[52:55], s59 offen offset:16 sc1
    s_waitcnt vmcnt(7)
    s_add_u32 m0, s14, 20480
    s_nop 0
    buffer_load_dwordx4 v1, s[44:47], s57 offen nt lds
    s_waitcnt vmcnt(7)
    buffer_load_dwordx4 v1, s[44:47], s57 offen offset:1024 nt lds
    s_waitcnt vmcnt(7)
    buffer_load_dwordx4 v1, s[44:47], s57 offen offset:2048 nt lds
    s_waitcnt vmcnt(7)
    buffer_load_dwordx4 v1, s[44:47], s57 offen offset:3072 nt lds
    s_add_u32 s57, s57, 16384
    s_waitcnt vmcnt(7)
    s_add_u32 m0, s14, 24576
    s_nop 0
    buffer_load_dwordx4 v1, s[44:47], s57 offen nt lds
    s_waitcnt vmcnt(7)
    buffer_load_dwordx4 v1, s[44:47], s57 offen offset:1024 nt lds
    s_waitcnt vmcnt(7)
    buffer_load_dwordx4 v1, s[44:47], s57 offen offset:2048 nt lds
    s_waitcnt vmcnt(7)
    buffer_load_dwordx4 v1, s[44:47], s57 offen offset:3072 nt lds
    s_add_u32 s57, s57, 16384
    s_waitcnt vmcnt(7)
    s_add_u32 m0, s14, 28672
    s_nop 0
    buffer_load_dwordx4 v1, s[44:47], s57 offen nt lds
    s_waitcnt vmcnt(7)
    buffer_load_dwordx4 v1, s[44:47], s57 offen offset:1024 nt lds
    s_waitcnt vmcnt(7)
    buffer_load_dwordx4 v1, s[44:47], s57 offen offset:2048 nt lds
    s_waitcnt vmcnt(7)
    buffer_load_dwordx4 v1, s[44:47], s57 offen offset:3072 nt lds
    s_add_u32 s57, s57, 16384
    s_waitcnt lgkmcnt(0)
    s_and_b32 s10, s56, 0x80808080
    s_and_b32 s56, s56, 0x7f7f7f7f
    s_add_u32 s56, s56, 0x07050301
    s_xor_b32 s56, s56, s10
    s_mov_b32 s15, 131072
L_qw:
    v_bitop3_b32 v16, v9, v11, s56 bitop3:0x7e
    v_bitop3_b32 v17, v13, v15, s56 bitop3:0x7e
    v_or_b32 v16, v16, v17
    v_cmp_ne_u32 vcc, 0, v16
    s_cbranch_vccz L_qok
    buffer_load_dwordx4 v[8:11], v58, s[52:55], s59 offen sc1
    buffer_load_dwordx4 v[12:15], v58, s[52:55], s59 offen offset:16 sc1
    s_waitcnt vmcnt(0)
    s_sub_u32 s15, s15, 1
    s_cmp_lg_u32 s15, 0
    s_cbranch_scc1 L_qw
L_qok:
    s_waitcnt vmcnt(7)
    buffer_load_dwordx4 v[240:243], v1, s[44:47], s57 offen nt
    v_cndmask_b32 v32, 0, v8, s[60:61]
    v_cndmask_b32 v33, 0, v10, s[60:61]
    v_cndmask_b32 v34, 0, v12, s[60:61]
    v_cndmask_b32 v35, 0, v14, s[60:61]
    v_cndmask_b32 v36, 0, v8, s[62:63]
    v_cndmask_b32 v37, 0, v10, s[62:63]
    v_cndmask_b32 v38, 0, v12, s[62:63]
    v_cndmask_b32 v39, 0, v14, s[62:63]
    v_cndmask_b32 v40, 0, v8, s[64:65]
    v_cndmask_b32 v41, 0, v10, s[64:65]
    v_cndmask_b32 v42, 0, v12, s[64:65]
    v_cndmask_b32 v43, 0, v14, s[64:65]
    v_cndmask_b32 v44, 0, v8, s[66:67]
    v_cndmask_b32 v45, 0, v10, s[66:67]
    v_cndmask_b32 v46, 0, v12, s[66:67]
    v_cndmask_b32 v47, 0, v14, s[66:67]
    s_mov_b32 s59, 0x3db504f3
    v_mfma_f32_16x16x32_bf16 v[8:11], v[64:67], v[32:35], 0
    v_mfma_f32_16x16x32_bf16 v[8:11], v[68:71], v[36:39], v[8:11]
    v_mfma_f32_16x16x32_bf16 v[8:11], v[72:75], v[40:43], v[8:11]
    v_mfma_f32_16x16x32_bf16 v[8:11], v[76:79], v[44:47], v[8:11]
    v_mfma_f32_16x16x32_bf16 v[12:15], v[80:83], v[32:35], 0
    v_mfma_f32_16x16x32_bf16 v[12:15], v[84:87], v[36:39], v[12:15]
    v_mfma_f32_16x16x32_bf16 v[12:15], v[88:91], v[40:43], v[12:15]
    v_mfma_f32_16x16x32_bf16 v[12:15], v[92:95], v[44:47], v[12:15]
    v_mfma_f32_16x16x32_bf16 v[16:19], v[96:99], v[32:35], 0
    v_mfma_f32_16x16x32_bf16 v[16:19], v[100:103], v[36:39], v[16:19]
    v_mfma_f32_16x16x32_bf16 v[16:19], v[104:107], v[40:43], v[16:19]
    v_mfma_f32_16x16x32_bf16 v[16:19], v[108:111], v[44:47], v[16:19]
    s_waitcnt vmcnt(7)
    buffer_load_dwordx4 v[244:247], v1, s[44:47], s57 offen offset:1024 nt
    v_mfma_f32_16x16x32_bf16 v[20:23], v[112:115], v[32:35], 0
    v_mfma_f32_16x16x32_bf16 v[20:23], v[116:119], v[36:39], v[20:23]
    v_mfma_f32_16x16x32_bf16 v[20:23], v[120:123], v[40:43], v[20:23]
    v_mfma_f32_16x16x32_bf16 v[20:23], v[124:127], v[44:47], v[20:23]
    v_mov_b32_dpp v24, v8 quad_perm:[0,0,0,0] row_mask:0xf bank_mask:0xf
    v_mov_b32_dpp v25, v12 quad_perm:[0,0,0,0] row_mask:0xf bank_mask:0xf
    v_mov_b32_dpp v26, v16 quad_perm:[0,0,0,0] row_mask:0xf bank_mask:0xf
    s_nop 4
    v_mov_b32_dpp v27, v20 quad_perm:[0,0,0,0] row_mask:0xf bank_mask:0xf
    v_add_f32_dpp v24, v9, v24 quad_perm:[1,1,1,1] row_mask:0xf bank_mask:0xf
    v_add_f32_dpp v25, v13, v25 quad_perm:[1,1,1,1] row_mask:0xf bank_mask:0xf
    v_add_f32_dpp v26, v17, v26 quad_perm:[1,1,1,1] row_mask:0xf bank_mask:0xf
    v_add_f32_dpp v27, v21, v27 quad_perm:[1,1,1,1] row_mask:0xf bank_mask:0xf
    v_add_f32_dpp v24, v10, v24 quad_perm:[2,2,2,2] row_mask:0xf bank_mask:0xf
    v_add_f32_dpp v25, v14, v25 quad_perm:[2,2,2,2] row_mask:0xf bank_mask:0xf
    v_add_f32_dpp v26, v18, v26 quad_perm:[2,2,2,2] row_mask:0xf bank_mask:0xf
    v_add_f32_dpp v27, v22, v27 quad_perm:[2,2,2,2] row_mask:0xf bank_mask:0xf
    v_add_f32_dpp v24, v11, v24 quad_perm:[3,3,3,3] row_mask:0xf bank_mask:0xf
    v_add_f32_dpp v25, v15, v25 quad_perm:[3,3,3,3] row_mask:0xf bank_mask:0xf
    v_add_f32_dpp v26, v19, v26 quad_perm:[3,3,3,3] row_mask:0xf bank_mask:0xf
    v_add_f32_dpp v27, v23, v27 quad_perm:[3,3,3,3] row_mask:0xf bank_mask:0xf
    v_cndmask_b32 v24, v24, v25, s[68:69]
    v_cndmask_b32 v26, v26, v27, s[68:69]
    v_cndmask_b32 v24, v24, v26, s[70:71]
    v_cvt_pk_bf16_f32 v24, v24, v24
    v_and_b32 v24, 0xffff0000, v24
    v_mul_f32 v24, s59, v24
    v_cvt_pk_bf16_f32 v24, v24, v24
    v_and_b32 v48, 0xffff0000, v24
    v_max_f32 v57, v57, v48
    v_mfma_f32_16x16x32_bf16 v[8:11], v[128:131], v[32:35], 0
    v_mfma_f32_16x16x32_bf16 v[8:11], v[132:135], v[36:39], v[8:11]
    v_mfma_f32_16x16x32_bf16 v[8:11], v[136:139], v[40:43], v[8:11]
    v_mfma_f32_16x16x32_bf16 v[8:11], v[140:143], v[44:47], v[8:11]
    v_mfma_f32_16x16x32_bf16 v[12:15], v[144:147], v[32:35], 0
    v_mfma_f32_16x16x32_bf16 v[12:15], v[148:151], v[36:39], v[12:15]
    v_mfma_f32_16x16x32_bf16 v[12:15], v[152:155], v[40:43], v[12:15]
    v_mfma_f32_16x16x32_bf16 v[12:15], v[156:159], v[44:47], v[12:15]
    s_waitcnt vmcnt(7)
    buffer_load_dwordx4 v[248:251], v1, s[44:47], s57 offen offset:2048 nt
    v_mfma_f32_16x16x32_bf16 v[16:19], v[160:163], v[32:35], 0
    v_mfma_f32_16x16x32_bf16 v[16:19], v[164:167], v[36:39], v[16:19]
    v_mfma_f32_16x16x32_bf16 v[16:19], v[168:171], v[40:43], v[16:19]
    v_mfma_f32_16x16x32_bf16 v[16:19], v[172:175], v[44:47], v[16:19]
    v_mfma_f32_16x16x32_bf16 v[20:23], v[176:179], v[32:35], 0
    v_mfma_f32_16x16x32_bf16 v[20:23], v[180:183], v[36:39], v[20:23]
    v_mfma_f32_16x16x32_bf16 v[20:23], v[184:187], v[40:43], v[20:23]
    v_mfma_f32_16x16x32_bf16 v[20:23], v[188:191], v[44:47], v[20:23]
    v_mov_b32_dpp v24, v8 quad_perm:[0,0,0,0] row_mask:0xf bank_mask:0xf
    v_mov_b32_dpp v25, v12 quad_perm:[0,0,0,0] row_mask:0xf bank_mask:0xf
    s_nop 1
    v_mov_b32_dpp v26, v16 quad_perm:[0,0,0,0] row_mask:0xf bank_mask:0xf
    s_nop 2
    v_mov_b32_dpp v27, v20 quad_perm:[0,0,0,0] row_mask:0xf bank_mask:0xf
    v_add_f32_dpp v24, v9, v24 quad_perm:[1,1,1,1] row_mask:0xf bank_mask:0xf
    v_add_f32_dpp v25, v13, v25 quad_perm:[1,1,1,1] row_mask:0xf bank_mask:0xf
    v_add_f32_dpp v26, v17, v26 quad_perm:[1,1,1,1] row_mask:0xf bank_mask:0xf
    v_add_f32_dpp v27, v21, v27 quad_perm:[1,1,1,1] row_mask:0xf bank_mask:0xf
    v_add_f32_dpp v24, v10, v24 quad_perm:[2,2,2,2] row_mask:0xf bank_mask:0xf
    v_add_f32_dpp v25, v14, v25 quad_perm:[2,2,2,2] row_mask:0xf bank_mask:0xf
    v_add_f32_dpp v26, v18, v26 quad_perm:[2,2,2,2] row_mask:0xf bank_mask:0xf
    v_add_f32_dpp v27, v22, v27 quad_perm:[2,2,2,2] row_mask:0xf bank_mask:0xf
    v_add_f32_dpp v24, v11, v24 quad_perm:[3,3,3,3] row_mask:0xf bank_mask:0xf
    v_add_f32_dpp v25, v15, v25 quad_perm:[3,3,3,3] row_mask:0xf bank_mask:0xf
    v_add_f32_dpp v26, v19, v26 quad_perm:[3,3,3,3] row_mask:0xf bank_mask:0xf
    v_add_f32_dpp v27, v23, v27 quad_perm:[3,3,3,3] row_mask:0xf bank_mask:0xf
    v_cndmask_b32 v24, v24, v25, s[68:69]
    v_cndmask_b32 v26, v26, v27, s[68:69]
    v_cndmask_b32 v24, v24, v26, s[70:71]
    v_cvt_pk_bf16_f32 v24, v24, v24
    v_and_b32 v24, 0xffff0000, v24
    v_mul_f32 v24, s59, v24
    v_cvt_pk_bf16_f32 v24, v24, v24
    v_and_b32 v49, 0xffff0000, v24
    v_max_f32 v57, v57, v49
    v_mfma_f32_16x16x32_bf16 v[8:11], v[192:195], v[32:35], 0
    v_mfma_f32_16x16x32_bf16 v[8:11], v[196:199], v[36:39], v[8:11]
    v_mfma_f32_16x16x32_bf16 v[8:11], v[200:203], v[40:43], v[8:11]
    v_mfma_f32_16x16x32_bf16 v[8:11], v[204:207], v[44:47], v[8:11]
    s_waitcnt vmcnt(7)
    buffer_load_dwordx4 v[252:255], v1, s[44:47], s57 offen offset:3072 nt
    s_add_u32 s57, s57, 16384
    v_mfma_f32_16x16x32_bf16 v[12:15], v[208:211], v[32:35], 0
    v_mfma_f32_16x16x32_bf16 v[12:15], v[212:215], v[36:39], v[12:15]
    v_mfma_f32_16x16x32_bf16 v[12:15], v[216:219], v[40:43], v[12:15]
    v_mfma_f32_16x16x32_bf16 v[12:15], v[220:223], v[44:47], v[12:15]
    v_mfma_f32_16x16x32_bf16 v[16:19], v[224:227], v[32:35], 0
    v_mfma_f32_16x16x32_bf16 v[16:19], v[228:231], v[36:39], v[16:19]
    v_mfma_f32_16x16x32_bf16 v[16:19], v[232:235], v[40:43], v[16:19]
    v_mfma_f32_16x16x32_bf16 v[16:19], v[236:239], v[44:47], v[16:19]
    ds_read_b128 v[160:163], v59 offset:0
    ds_read_b128 v[164:167], v59 offset:1024
    ds_read_b128 v[168:171], v59 offset:2048
    ds_read_b128 v[172:175], v59 offset:3072
    s_waitcnt lgkmcnt(3)
    v_mfma_f32_16x16x32_bf16 v[20:23], v[160:163], v[32:35], 0
    s_waitcnt lgkmcnt(2)
    v_mfma_f32_16x16x32_bf16 v[20:23], v[164:167], v[36:39], v[20:23]
    s_waitcnt lgkmcnt(1)
    v_mfma_f32_16x16x32_bf16 v[20:23], v[168:171], v[40:43], v[20:23]
    s_waitcnt lgkmcnt(0)
    v_mfma_f32_16x16x32_bf16 v[20:23], v[172:175], v[44:47], v[20:23]
    v_mov_b32_dpp v24, v8 quad_perm:[0,0,0,0] row_mask:0xf bank_mask:0xf
    v_mov_b32_dpp v25, v12 quad_perm:[0,0,0,0] row_mask:0xf bank_mask:0xf
    v_mov_b32_dpp v26, v16 quad_perm:[0,0,0,0] row_mask:0xf bank_mask:0xf
    s_nop 4
    v_mov_b32_dpp v27, v20 quad_perm:[0,0,0,0] row_mask:0xf bank_mask:0xf
    v_add_f32_dpp v24, v9, v24 quad_perm:[1,1,1,1] row_mask:0xf bank_mask:0xf
    v_add_f32_dpp v25, v13, v25 quad_perm:[1,1,1,1] row_mask:0xf bank_mask:0xf
    v_add_f32_dpp v26, v17, v26 quad_perm:[1,1,1,1] row_mask:0xf bank_mask:0xf
    v_add_f32_dpp v27, v21, v27 quad_perm:[1,1,1,1] row_mask:0xf bank_mask:0xf
    v_add_f32_dpp v24, v10, v24 quad_perm:[2,2,2,2] row_mask:0xf bank_mask:0xf
    v_add_f32_dpp v25, v14, v25 quad_perm:[2,2,2,2] row_mask:0xf bank_mask:0xf
    v_add_f32_dpp v26, v18, v26 quad_perm:[2,2,2,2] row_mask:0xf bank_mask:0xf
    v_add_f32_dpp v27, v22, v27 quad_perm:[2,2,2,2] row_mask:0xf bank_mask:0xf
    v_add_f32_dpp v24, v11, v24 quad_perm:[3,3,3,3] row_mask:0xf bank_mask:0xf
    v_add_f32_dpp v25, v15, v25 quad_perm:[3,3,3,3] row_mask:0xf bank_mask:0xf
    v_add_f32_dpp v26, v19, v26 quad_perm:[3,3,3,3] row_mask:0xf bank_mask:0xf
    v_add_f32_dpp v27, v23, v27 quad_perm:[3,3,3,3] row_mask:0xf bank_mask:0xf
    v_cndmask_b32 v24, v24, v25, s[68:69]
    v_cndmask_b32 v26, v26, v27, s[68:69]
    v_cndmask_b32 v24, v24, v26, s[70:71]
    v_cvt_pk_bf16_f32 v24, v24, v24
    v_and_b32 v24, 0xffff0000, v24
    v_mul_f32 v24, s59, v24
    v_cvt_pk_bf16_f32 v24, v24, v24
    v_and_b32 v50, 0xffff0000, v24
    v_max_f32 v57, v57, v50
    s_waitcnt vmcnt(7)
    buffer_load_dwordx4 v[64:67], v1, s[44:47], s57 offen nt
    ds_read_b128 v[160:163], v59 offset:4096
    ds_read_b128 v[164:167], v59 offset:5120
    ds_read_b128 v[168:171], v59 offset:6144
    ds_read_b128 v[172:175], v59 offset:7168
    s_waitcnt lgkmcnt(3)
    v_mfma_f32_16x16x32_bf16 v[8:11], v[160:163], v[32:35], 0
    s_waitcnt lgkmcnt(2)
    v_mfma_f32_16x16x32_bf16 v[8:11], v[164:167], v[36:39], v[8:11]
    s_waitcnt lgkmcnt(1)
    v_mfma_f32_16x16x32_bf16 v[8:11], v[168:171], v[40:43], v[8:11]
    s_waitcnt lgkmcnt(0)
    v_mfma_f32_16x16x32_bf16 v[8:11], v[172:175], v[44:47], v[8:11]
    ds_read_b128 v[160:163], v59 offset:8192
    ds_read_b128 v[164:167], v59 offset:9216
    ds_read_b128 v[168:171], v59 offset:10240
    ds_read_b128 v[172:175], v59 offset:11264
    s_waitcnt lgkmcnt(3)
    v_mfma_f32_16x16x32_bf16 v[12:15], v[160:163], v[32:35], 0
    s_waitcnt lgkmcnt(2)
    v_mfma_f32_16x16x32_bf16 v[12:15], v[164:167], v[36:39], v[12:15]
    s_waitcnt lgkmcnt(1)
    v_mfma_f32_16x16x32_bf16 v[12:15], v[168:171], v[40:43], v[12:15]
    s_waitcnt lgkmcnt(0)
    v_mfma_f32_16x16x32_bf16 v[12:15], v[172:175], v[44:47], v[12:15]
    ds_read_b128 v[160:163], v59 offset:12288
    ds_read_b128 v[164:167], v59 offset:13312
    ds_read_b128 v[168:171], v59 offset:14336
    ds_read_b128 v[172:175], v59 offset:15360
    s_waitcnt lgkmcnt(3)
    v_mfma_f32_16x16x32_bf16 v[16:19], v[160:163], v[32:35], 0
    s_waitcnt lgkmcnt(2)
    v_mfma_f32_16x16x32_bf16 v[16:19], v[164:167], v[36:39], v[16:19]
    s_waitcnt lgkmcnt(1)
    v_mfma_f32_16x16x32_bf16 v[16:19], v[168:171], v[40:43], v[16:19]
    s_waitcnt lgkmcnt(0)
    v_mfma_f32_16x16x32_bf16 v[16:19], v[172:175], v[44:47], v[16:19]
    s_waitcnt vmcnt(7)
    buffer_load_dwordx4 v[68:71], v1, s[44:47], s57 offen offset:1024 nt
    ds_read_b128 v[160:163], v59 offset:16384
    ds_read_b128 v[164:167], v59 offset:17408
    ds_read_b128 v[168:171], v59 offset:18432
    ds_read_b128 v[172:175], v59 offset:19456
    s_waitcnt lgkmcnt(3)
    v_mfma_f32_16x16x32_bf16 v[20:23], v[160:163], v[32:35], 0
    s_waitcnt lgkmcnt(2)
    v_mfma_f32_16x16x32_bf16 v[20:23], v[164:167], v[36:39], v[20:23]
    s_waitcnt lgkmcnt(1)
    v_mfma_f32_16x16x32_bf16 v[20:23], v[168:171], v[40:43], v[20:23]
    s_waitcnt lgkmcnt(0)
    v_mfma_f32_16x16x32_bf16 v[20:23], v[172:175], v[44:47], v[20:23]
    v_mov_b32_dpp v24, v8 quad_perm:[0,0,0,0] row_mask:0xf bank_mask:0xf
    v_mov_b32_dpp v25, v12 quad_perm:[0,0,0,0] row_mask:0xf bank_mask:0xf
    v_mov_b32_dpp v26, v16 quad_perm:[0,0,0,0] row_mask:0xf bank_mask:0xf
    s_nop 4
    v_mov_b32_dpp v27, v20 quad_perm:[0,0,0,0] row_mask:0xf bank_mask:0xf
    v_add_f32_dpp v24, v9, v24 quad_perm:[1,1,1,1] row_mask:0xf bank_mask:0xf
    v_add_f32_dpp v25, v13, v25 quad_perm:[1,1,1,1] row_mask:0xf bank_mask:0xf
    v_add_f32_dpp v26, v17, v26 quad_perm:[1,1,1,1] row_mask:0xf bank_mask:0xf
    v_add_f32_dpp v27, v21, v27 quad_perm:[1,1,1,1] row_mask:0xf bank_mask:0xf
    v_add_f32_dpp v24, v10, v24 quad_perm:[2,2,2,2] row_mask:0xf bank_mask:0xf
    v_add_f32_dpp v25, v14, v25 quad_perm:[2,2,2,2] row_mask:0xf bank_mask:0xf
    v_add_f32_dpp v26, v18, v26 quad_perm:[2,2,2,2] row_mask:0xf bank_mask:0xf
    v_add_f32_dpp v27, v22, v27 quad_perm:[2,2,2,2] row_mask:0xf bank_mask:0xf
    v_add_f32_dpp v24, v11, v24 quad_perm:[3,3,3,3] row_mask:0xf bank_mask:0xf
    v_add_f32_dpp v25, v15, v25 quad_perm:[3,3,3,3] row_mask:0xf bank_mask:0xf
    v_add_f32_dpp v26, v19, v26 quad_perm:[3,3,3,3] row_mask:0xf bank_mask:0xf
    v_add_f32_dpp v27, v23, v27 quad_perm:[3,3,3,3] row_mask:0xf bank_mask:0xf
    v_cndmask_b32 v24, v24, v25, s[68:69]
    v_cndmask_b32 v26, v26, v27, s[68:69]
    v_cndmask_b32 v24, v24, v26, s[70:71]
    v_cvt_pk_bf16_f32 v24, v24, v24
    v_and_b32 v24, 0xffff0000, v24
    v_mul_f32 v24, s59, v24
    v_cvt_pk_bf16_f32 v24, v24, v24
    v_and_b32 v51, 0xffff0000, v24
    v_max_f32 v57, v57, v51
    ds_read_b128 v[160:163], v59 offset:20480
    ds_read_b128 v[164:167], v59 offset:21504
    ds_read_b128 v[168:171], v59 offset:22528
    ds_read_b128 v[172:175], v59 offset:23552
    s_waitcnt lgkmcnt(3)
    v_mfma_f32_16x16x32_bf16 v[8:11], v[160:163], v[32:35], 0
    s_waitcnt lgkmcnt(2)
    v_mfma_f32_16x16x32_bf16 v[8:11], v[164:167], v[36:39], v[8:11]
    s_waitcnt lgkmcnt(1)
    v_mfma_f32_16x16x32_bf16 v[8:11], v[168:171], v[40:43], v[8:11]
    s_waitcnt lgkmcnt(0)
    v_mfma_f32_16x16x32_bf16 v[8:11], v[172:175], v[44:47], v[8:11]
    ds_read_b128 v[160:163], v59 offset:24576
    ds_read_b128 v[164:167], v59 offset:25600
    ds_read_b128 v[168:171], v59 offset:26624
    ds_read_b128 v[172:175], v59 offset:27648
    s_waitcnt lgkmcnt(3)
    v_mfma_f32_16x16x32_bf16 v[12:15], v[160:163], v[32:35], 0
    s_waitcnt lgkmcnt(2)
    v_mfma_f32_16x16x32_bf16 v[12:15], v[164:167], v[36:39], v[12:15]
    s_waitcnt lgkmcnt(1)
    v_mfma_f32_16x16x32_bf16 v[12:15], v[168:171], v[40:43], v[12:15]
    s_waitcnt lgkmcnt(0)
    v_mfma_f32_16x16x32_bf16 v[12:15], v[172:175], v[44:47], v[12:15]
    s_waitcnt vmcnt(7)
    buffer_load_dwordx4 v[72:75], v1, s[44:47], s57 offen offset:2048 nt
    s_waitcnt vmcnt(7)
    buffer_load_dwordx4 v[76:79], v1, s[44:47], s57 offen offset:3072 nt
    s_add_u32 s57, s57, 16384
    ds_read_b128 v[160:163], v59 offset:28672
    ds_read_b128 v[164:167], v59 offset:29696
    ds_read_b128 v[168:171], v59 offset:30720
    ds_read_b128 v[172:175], v59 offset:31744
    s_waitcnt lgkmcnt(3)
    v_mfma_f32_16x16x32_bf16 v[16:19], v[160:163], v[32:35], 0
    s_waitcnt lgkmcnt(2)
    v_mfma_f32_16x16x32_bf16 v[16:19], v[164:167], v[36:39], v[16:19]
    s_waitcnt lgkmcnt(1)
    v_mfma_f32_16x16x32_bf16 v[16:19], v[168:171], v[40:43], v[16:19]
    s_waitcnt lgkmcnt(0)
    v_mfma_f32_16x16x32_bf16 v[16:19], v[172:175], v[44:47], v[16:19]
    v_mov_b32 v60, 0
    v_mov_b32 v61, 1
    s_mov_b64 exec, 1
    ds_add_u32 v60, v61 offset:12
    s_mov_b64 exec, -1
    s_waitcnt vmcnt(7)
    buffer_load_dwordx4 v[80:83], v1, s[44:47], s57 offen nt
    v_mfma_f32_16x16x32_bf16 v[20:23], v[240:243], v[32:35], 0
    s_waitcnt vmcnt(7)
    buffer_load_dwordx4 v[84:87], v1, s[44:47], s57 offen offset:1024 nt
    v_mfma_f32_16x16x32_bf16 v[20:23], v[244:247], v[36:39], v[20:23]
    s_waitcnt vmcnt(7)
    buffer_load_dwordx4 v[88:91], v1, s[44:47], s57 offen offset:2048 nt
    v_mfma_f32_16x16x32_bf16 v[20:23], v[248:251], v[40:43], v[20:23]
    s_waitcnt vmcnt(7)
    buffer_load_dwordx4 v[92:95], v1, s[44:47], s57 offen offset:3072 nt
    s_add_u32 s57, s57, 16384
    v_mfma_f32_16x16x32_bf16 v[20:23], v[252:255], v[44:47], v[20:23]
    v_mov_b32_dpp v24, v8 quad_perm:[0,0,0,0] row_mask:0xf bank_mask:0xf
    v_mov_b32_dpp v25, v12 quad_perm:[0,0,0,0] row_mask:0xf bank_mask:0xf
    v_mov_b32_dpp v26, v16 quad_perm:[0,0,0,0] row_mask:0xf bank_mask:0xf
    s_nop 4
    v_mov_b32_dpp v27, v20 quad_perm:[0,0,0,0] row_mask:0xf bank_mask:0xf
    v_add_f32_dpp v24, v9, v24 quad_perm:[1,1,1,1] row_mask:0xf bank_mask:0xf
    v_add_f32_dpp v25, v13, v25 quad_perm:[1,1,1,1] row_mask:0xf bank_mask:0xf
    v_add_f32_dpp v26, v17, v26 quad_perm:[1,1,1,1] row_mask:0xf bank_mask:0xf
    v_add_f32_dpp v27, v21, v27 quad_perm:[1,1,1,1] row_mask:0xf bank_mask:0xf
    v_add_f32_dpp v24, v10, v24 quad_perm:[2,2,2,2] row_mask:0xf bank_mask:0xf
    v_add_f32_dpp v25, v14, v25 quad_perm:[2,2,2,2] row_mask:0xf bank_mask:0xf
    v_add_f32_dpp v26, v18, v26 quad_perm:[2,2,2,2] row_mask:0xf bank_mask:0xf
    v_add_f32_dpp v27, v22, v27 quad_perm:[2,2,2,2] row_mask:0xf bank_mask:0xf
    v_add_f32_dpp v24, v11, v24 quad_perm:[3,3,3,3] row_mask:0xf bank_mask:0xf
    v_add_f32_dpp v25, v15, v25 quad_perm:[3,3,3,3] row_mask:0xf bank_mask:0xf
    v_add_f32_dpp v26, v19, v26 quad_perm:[3,3,3,3] row_mask:0xf bank_mask:0xf
    v_add_f32_dpp v27, v23, v27 quad_perm:[3,3,3,3] row_mask:0xf bank_mask:0xf
    v_cndmask_b32 v24, v24, v25, s[68:69]
    v_cndmask_b32 v26, v26, v27, s[68:69]
    v_cndmask_b32 v24, v24, v26, s[70:71]
    v_cvt_pk_bf16_f32 v24, v24, v24
    v_and_b32 v24, 0xffff0000, v24
    v_mul_f32 v24, s59, v24
    v_cvt_pk_bf16_f32 v24, v24, v24
    v_and_b32 v52, 0xffff0000, v24
    v_max_f32 v57, v57, v52
    s_waitcnt vmcnt(7)
    buffer_load_dwordx4 v[96:99], v1, s[44:47], s57 offen nt
    v_mfma_f32_16x16x32_bf16 v[8:11], v[64:67], v[32:35], 0
    s_waitcnt vmcnt(7)
    buffer_load_dwordx4 v[100:103], v1, s[44:47], s57 offen offset:1024 nt
    v_mfma_f32_16x16x32_bf16 v[8:11], v[68:71], v[36:39], v[8:11]
    s_waitcnt vmcnt(7)
    buffer_load_dwordx4 v[104:107], v1, s[44:47], s57 offen offset:2048 nt
    v_mfma_f32_16x16x32_bf16 v[8:11], v[72:75], v[40:43], v[8:11]
    s_waitcnt vmcnt(7)
    buffer_load_dwordx4 v[108:111], v1, s[44:47], s57 offen offset:3072 nt
    s_add_u32 s57, s57, 16384
    v_mfma_f32_16x16x32_bf16 v[8:11], v[76:79], v[44:47], v[8:11]
    s_waitcnt vmcnt(7)
    buffer_load_dwordx4 v[112:115], v1, s[44:47], s57 offen nt
    v_mfma_f32_16x16x32_bf16 v[12:15], v[80:83], v[32:35], 0
    s_waitcnt vmcnt(7)
    buffer_load_dwordx4 v[116:119], v1, s[44:47], s57 offen offset:1024 nt
    v_mfma_f32_16x16x32_bf16 v[12:15], v[84:87], v[36:39], v[12:15]
    s_waitcnt vmcnt(7)
    buffer_load_dwordx4 v[120:123], v1, s[44:47], s57 offen offset:2048 nt
    v_mfma_f32_16x16x32_bf16 v[12:15], v[88:91], v[40:43], v[12:15]
    s_waitcnt vmcnt(7)
    buffer_load_dwordx4 v[124:127], v1, s[44:47], s57 offen offset:3072 nt
    s_add_u32 s57, s57, 16384
    v_mfma_f32_16x16x32_bf16 v[12:15], v[92:95], v[44:47], v[12:15]
    s_waitcnt vmcnt(7)
    buffer_load_dwordx4 v[128:131], v1, s[44:47], s57 offen nt
    v_mfma_f32_16x16x32_bf16 v[16:19], v[96:99], v[32:35], 0
    s_waitcnt vmcnt(7)
    buffer_load_dwordx4 v[132:135], v1, s[44:47], s57 offen offset:1024 nt
    v_mfma_f32_16x16x32_bf16 v[16:19], v[100:103], v[36:39], v[16:19]
    s_waitcnt vmcnt(7)
    buffer_load_dwordx4 v[136:139], v1, s[44:47], s57 offen offset:2048 nt
    v_mfma_f32_16x16x32_bf16 v[16:19], v[104:107], v[40:43], v[16:19]
    s_waitcnt vmcnt(7)
    buffer_load_dwordx4 v[140:143], v1, s[44:47], s57 offen offset:3072 nt
    s_add_u32 s57, s57, 16384
    v_mfma_f32_16x16x32_bf16 v[16:19], v[108:111], v[44:47], v[16:19]
    s_waitcnt vmcnt(7)
    buffer_load_dwordx4 v[144:147], v1, s[44:47], s57 offen nt
    v_mfma_f32_16x16x32_bf16 v[20:23], v[112:115], v[32:35], 0
    s_waitcnt vmcnt(7)
    buffer_load_dwordx4 v[148:151], v1, s[44:47], s57 offen offset:1024 nt
    v_mfma_f32_16x16x32_bf16 v[20:23], v[116:119], v[36:39], v[20:23]
    s_waitcnt vmcnt(7)
    buffer_load_dwordx4 v[152:155], v1, s[44:47], s57 offen offset:2048 nt
    v_mfma_f32_16x16x32_bf16 v[20:23], v[120:123], v[40:43], v[20:23]
    s_waitcnt vmcnt(7)
    buffer_load_dwordx4 v[156:159], v1, s[44:47], s57 offen offset:3072 nt
    s_add_u32 s57, s57, 16384
    v_mfma_f32_16x16x32_bf16 v[20:23], v[124:127], v[44:47], v[20:23]
    v_mov_b32_dpp v24, v8 quad_perm:[0,0,0,0] row_mask:0xf bank_mask:0xf
    v_mov_b32_dpp v25, v12 quad_perm:[0,0,0,0] row_mask:0xf bank_mask:0xf
    v_mov_b32_dpp v26, v16 quad_perm:[0,0,0,0] row_mask:0xf bank_mask:0xf
    s_nop 4
    v_mov_b32_dpp v27, v20 quad_perm:[0,0,0,0] row_mask:0xf bank_mask:0xf
    v_add_f32_dpp v24, v9, v24 quad_perm:[1,1,1,1] row_mask:0xf bank_mask:0xf
    v_add_f32_dpp v25, v13, v25 quad_perm:[1,1,1,1] row_mask:0xf bank_mask:0xf
    v_add_f32_dpp v26, v17, v26 quad_perm:[1,1,1,1] row_mask:0xf bank_mask:0xf
    v_add_f32_dpp v27, v21, v27 quad_perm:[1,1,1,1] row_mask:0xf bank_mask:0xf
    v_add_f32_dpp v24, v10, v24 quad_perm:[2,2,2,2] row_mask:0xf bank_mask:0xf
    v_add_f32_dpp v25, v14, v25 quad_perm:[2,2,2,2] row_mask:0xf bank_mask:0xf
    v_add_f32_dpp v26, v18, v26 quad_perm:[2,2,2,2] row_mask:0xf bank_mask:0xf
    v_add_f32_dpp v27, v22, v27 quad_perm:[2,2,2,2] row_mask:0xf bank_mask:0xf
    v_add_f32_dpp v24, v11, v24 quad_perm:[3,3,3,3] row_mask:0xf bank_mask:0xf
    v_add_f32_dpp v25, v15, v25 quad_perm:[3,3,3,3] row_mask:0xf bank_mask:0xf
    v_add_f32_dpp v26, v19, v26 quad_perm:[3,3,3,3] row_mask:0xf bank_mask:0xf
    v_add_f32_dpp v27, v23, v27 quad_perm:[3,3,3,3] row_mask:0xf bank_mask:0xf
    v_cndmask_b32 v24, v24, v25, s[68:69]
    v_cndmask_b32 v26, v26, v27, s[68:69]
    v_cndmask_b32 v24, v24, v26, s[70:71]
    v_cvt_pk_bf16_f32 v24, v24, v24
    v_and_b32 v24, 0xffff0000, v24
    v_mul_f32 v24, s59, v24
    v_cvt_pk_bf16_f32 v24, v24, v24
    v_and_b32 v53, 0xffff0000, v24
    v_max_f32 v57, v57, v53
    s_waitcnt vmcnt(7)
    buffer_load_dwordx4 v[160:163], v1, s[44:47], s57 offen nt
    v_mfma_f32_16x16x32_bf16 v[8:11], v[128:131], v[32:35], 0
    s_waitcnt vmcnt(7)
    buffer_load_dwordx4 v[164:167], v1, s[44:47], s57 offen offset:1024 nt
    v_mfma_f32_16x16x32_bf16 v[8:11], v[132:135], v[36:39], v[8:11]
    s_waitcnt vmcnt(7)
    buffer_load_dwordx4 v[168:171], v1, s[44:47], s57 offen offset:2048 nt
    v_mfma_f32_16x16x32_bf16 v[8:11], v[136:139], v[40:43], v[8:11]
    s_waitcnt vmcnt(7)
    buffer_load_dwordx4 v[172:175], v1, s[44:47], s57 offen offset:3072 nt
    s_add_u32 s57, s57, 16384
    v_mfma_f32_16x16x32_bf16 v[8:11], v[140:143], v[44:47], v[8:11]
    s_waitcnt vmcnt(7)
    buffer_load_dwordx4 v[176:179], v1, s[44:47], s57 offen nt
    v_mfma_f32_16x16x32_bf16 v[12:15], v[144:147], v[32:35], 0
    s_waitcnt vmcnt(7)
    buffer_load_dwordx4 v[180:183], v1, s[44:47], s57 offen offset:1024 nt
    v_mfma_f32_16x16x32_bf16 v[12:15], v[148:151], v[36:39], v[12:15]
    s_waitcnt vmcnt(7)
    buffer_load_dwordx4 v[184:187], v1, s[44:47], s57 offen offset:2048 nt
    v_mfma_f32_16x16x32_bf16 v[12:15], v[152:155], v[40:43], v[12:15]
    s_waitcnt vmcnt(7)
    buffer_load_dwordx4 v[188:191], v1, s[44:47], s57 offen offset:3072 nt
    s_add_u32 s57, s57, 16384
    v_mfma_f32_16x16x32_bf16 v[12:15], v[156:159], v[44:47], v[12:15]
    s_waitcnt vmcnt(7)
    buffer_load_dwordx4 v[192:195], v1, s[44:47], s57 offen nt
    v_mfma_f32_16x16x32_bf16 v[16:19], v[160:163], v[32:35], 0
    s_waitcnt vmcnt(7)
    buffer_load_dwordx4 v[196:199], v1, s[44:47], s57 offen offset:1024 nt
    v_mfma_f32_16x16x32_bf16 v[16:19], v[164:167], v[36:39], v[16:19]
    s_waitcnt vmcnt(7)
    buffer_load_dwordx4 v[200:203], v1, s[44:47], s57 offen offset:2048 nt
    v_mfma_f32_16x16x32_bf16 v[16:19], v[168:171], v[40:43], v[16:19]
    s_waitcnt vmcnt(7)
    buffer_load_dwordx4 v[204:207], v1, s[44:47], s57 offen offset:3072 nt
    s_add_u32 s57, s57, 16384
    v_mfma_f32_16x16x32_bf16 v[16:19], v[172:175], v[44:47], v[16:19]
    s_waitcnt vmcnt(7)
    buffer_load_dwordx4 v[208:211], v1, s[44:47], s57 offen nt
    v_mfma_f32_16x16x32_bf16 v[20:23], v[176:179], v[32:35], 0
    s_waitcnt vmcnt(7)
    buffer_load_dwordx4 v[212:215], v1, s[44:47], s57 offen offset:1024 nt
    v_mfma_f32_16x16x32_bf16 v[20:23], v[180:183], v[36:39], v[20:23]
    s_waitcnt vmcnt(7)
    buffer_load_dwordx4 v[216:219], v1, s[44:47], s57 offen offset:2048 nt
    v_mfma_f32_16x16x32_bf16 v[20:23], v[184:187], v[40:43], v[20:23]
    s_waitcnt vmcnt(7)
    buffer_load_dwordx4 v[220:223], v1, s[44:47], s57 offen offset:3072 nt
    s_add_u32 s57, s57, 16384
    v_mfma_f32_16x16x32_bf16 v[20:23], v[188:191], v[44:47], v[20:23]
    v_mov_b32_dpp v24, v8 quad_perm:[0,0,0,0] row_mask:0xf bank_mask:0xf
    v_mov_b32_dpp v25, v12 quad_perm:[0,0,0,0] row_mask:0xf bank_mask:0xf
    v_mov_b32_dpp v26, v16 quad_perm:[0,0,0,0] row_mask:0xf bank_mask:0xf
    s_nop 4
    v_mov_b32_dpp v27, v20 quad_perm:[0,0,0,0] row_mask:0xf bank_mask:0xf
    v_add_f32_dpp v24, v9, v24 quad_perm:[1,1,1,1] row_mask:0xf bank_mask:0xf
    v_add_f32_dpp v25, v13, v25 quad_perm:[1,1,1,1] row_mask:0xf bank_mask:0xf
    v_add_f32_dpp v26, v17, v26 quad_perm:[1,1,1,1] row_mask:0xf bank_mask:0xf
    v_add_f32_dpp v27, v21, v27 quad_perm:[1,1,1,1] row_mask:0xf bank_mask:0xf
    v_add_f32_dpp v24, v10, v24 quad_perm:[2,2,2,2] row_mask:0xf bank_mask:0xf
    v_add_f32_dpp v25, v14, v25 quad_perm:[2,2,2,2] row_mask:0xf bank_mask:0xf
    v_add_f32_dpp v26, v18, v26 quad_perm:[2,2,2,2] row_mask:0xf bank_mask:0xf
    v_add_f32_dpp v27, v22, v27 quad_perm:[2,2,2,2] row_mask:0xf bank_mask:0xf
    v_add_f32_dpp v24, v11, v24 quad_perm:[3,3,3,3] row_mask:0xf bank_mask:0xf
    v_add_f32_dpp v25, v15, v25 quad_perm:[3,3,3,3] row_mask:0xf bank_mask:0xf
    v_add_f32_dpp v26, v19, v26 quad_perm:[3,3,3,3] row_mask:0xf bank_mask:0xf
    v_add_f32_dpp v27, v23, v27 quad_perm:[3,3,3,3] row_mask:0xf bank_mask:0xf
    v_cndmask_b32 v24, v24, v25, s[68:69]
    v_cndmask_b32 v26, v26, v27, s[68:69]
    v_cndmask_b32 v24, v24, v26, s[70:71]
    v_cvt_pk_bf16_f32 v24, v24, v24
    v_and_b32 v24, 0xffff0000, v24
    v_mul_f32 v24, s59, v24
    v_cvt_pk_bf16_f32 v24, v24, v24
    v_and_b32 v54, 0xffff0000, v24
    v_max_f32 v57, v57, v54
    s_waitcnt vmcnt(7)
    buffer_load_dwordx4 v[224:227], v1, s[44:47], s57 offen nt
    v_mfma_f32_16x16x32_bf16 v[8:11], v[192:195], v[32:35], 0
    s_waitcnt vmcnt(7)
    buffer_load_dwordx4 v[228:231], v1, s[44:47], s57 offen offset:1024 nt
    v_mfma_f32_16x16x32_bf16 v[8:11], v[196:199], v[36:39], v[8:11]
    s_waitcnt vmcnt(7)
    buffer_load_dwordx4 v[232:235], v1, s[44:47], s57 offen offset:2048 nt
    v_mfma_f32_16x16x32_bf16 v[8:11], v[200:203], v[40:43], v[8:11]
    s_waitcnt vmcnt(7)
    buffer_load_dwordx4 v[236:239], v1, s[44:47], s57 offen offset:3072 nt
    s_add_u32 s57, s57, 16384
    v_mfma_f32_16x16x32_bf16 v[8:11], v[204:207], v[44:47], v[8:11]
    s_waitcnt vmcnt(7)
    buffer_load_dwordx4 v[240:243], v1, s[44:47], s57 offen nt
    v_mfma_f32_16x16x32_bf16 v[12:15], v[208:211], v[32:35], 0
    s_waitcnt vmcnt(7)
    buffer_load_dwordx4 v[244:247], v1, s[44:47], s57 offen offset:1024 nt
    v_mfma_f32_16x16x32_bf16 v[12:15], v[212:215], v[36:39], v[12:15]
    s_waitcnt vmcnt(7)
    buffer_load_dwordx4 v[248:251], v1, s[44:47], s57 offen offset:2048 nt
    v_mfma_f32_16x16x32_bf16 v[12:15], v[216:219], v[40:43], v[12:15]
    s_waitcnt vmcnt(7)
    buffer_load_dwordx4 v[252:255], v1, s[44:47], s57 offen offset:3072 nt
    s_add_u32 s57, s57, 16384
    v_mfma_f32_16x16x32_bf16 v[12:15], v[220:223], v[44:47], v[12:15]
    s_waitcnt vmcnt(7)
    buffer_load_dwordx4 v[64:67], v2, s[48:51], s58 offen nt
    v_mfma_f32_16x16x32_bf16 v[16:19], v[224:227], v[32:35], 0
    s_waitcnt vmcnt(7)
    buffer_load_dwordx4 v[68:71], v2, s[48:51], s58 offen offset:1024 nt
    v_mfma_f32_16x16x32_bf16 v[16:19], v[228:231], v[36:39], v[16:19]
    s_waitcnt vmcnt(7)
    buffer_load_dwordx4 v[72:75], v2, s[48:51], s58 offen offset:2048 nt
    v_mfma_f32_16x16x32_bf16 v[16:19], v[232:235], v[40:43], v[16:19]
    s_waitcnt vmcnt(7)
    buffer_load_dwordx4 v[76:79], v2, s[48:51], s58 offen offset:3072 nt
    s_add_u32 s58, s58, 16384
    v_mfma_f32_16x16x32_bf16 v[16:19], v[236:239], v[44:47], v[16:19]
    s_waitcnt vmcnt(7)
    buffer_load_dwordx4 v[80:83], v2, s[48:51], s58 offen nt
    v_mfma_f32_16x16x32_bf16 v[20:23], v[240:243], v[32:35], 0
    s_waitcnt vmcnt(7)
    buffer_load_dwordx4 v[84:87], v2, s[48:51], s58 offen offset:1024 nt
    v_mfma_f32_16x16x32_bf16 v[20:23], v[244:247], v[36:39], v[20:23]
    s_waitcnt vmcnt(7)
    buffer_load_dwordx4 v[88:91], v2, s[48:51], s58 offen offset:2048 nt
    v_mfma_f32_16x16x32_bf16 v[20:23], v[248:251], v[40:43], v[20:23]
    s_waitcnt vmcnt(7)
    buffer_load_dwordx4 v[92:95], v2, s[48:51], s58 offen offset:3072 nt
    s_add_u32 s58, s58, 16384
    v_mfma_f32_16x16x32_bf16 v[20:23], v[252:255], v[44:47], v[20:23]
    v_mov_b32_dpp v24, v8 quad_perm:[0,0,0,0] row_mask:0xf bank_mask:0xf
    v_mov_b32_dpp v25, v12 quad_perm:[0,0,0,0] row_mask:0xf bank_mask:0xf
    v_mov_b32_dpp v26, v16 quad_perm:[0,0,0,0] row_mask:0xf bank_mask:0xf
    s_nop 4
    v_mov_b32_dpp v27, v20 quad_perm:[0,0,0,0] row_mask:0xf bank_mask:0xf
    v_add_f32_dpp v24, v9, v24 quad_perm:[1,1,1,1] row_mask:0xf bank_mask:0xf
    v_add_f32_dpp v25, v13, v25 quad_perm:[1,1,1,1] row_mask:0xf bank_mask:0xf
    v_add_f32_dpp v26, v17, v26 quad_perm:[1,1,1,1] row_mask:0xf bank_mask:0xf
    v_add_f32_dpp v27, v21, v27 quad_perm:[1,1,1,1] row_mask:0xf bank_mask:0xf
    v_add_f32_dpp v24, v10, v24 quad_perm:[2,2,2,2] row_mask:0xf bank_mask:0xf
    v_add_f32_dpp v25, v14, v25 quad_perm:[2,2,2,2] row_mask:0xf bank_mask:0xf
    v_add_f32_dpp v26, v18, v26 quad_perm:[2,2,2,2] row_mask:0xf bank_mask:0xf
    v_add_f32_dpp v27, v22, v27 quad_perm:[2,2,2,2] row_mask:0xf bank_mask:0xf
    v_add_f32_dpp v24, v11, v24 quad_perm:[3,3,3,3] row_mask:0xf bank_mask:0xf
    v_add_f32_dpp v25, v15, v25 quad_perm:[3,3,3,3] row_mask:0xf bank_mask:0xf
    v_add_f32_dpp v26, v19, v26 quad_perm:[3,3,3,3] row_mask:0xf bank_mask:0xf
    v_add_f32_dpp v27, v23, v27 quad_perm:[3,3,3,3] row_mask:0xf bank_mask:0xf
    v_cndmask_b32 v24, v24, v25, s[68:69]
    v_cndmask_b32 v26, v26, v27, s[68:69]
    v_cndmask_b32 v24, v24, v26, s[70:71]
    v_cvt_pk_bf16_f32 v24, v24, v24
    v_and_b32 v24, 0xffff0000, v24
    v_mul_f32 v24, s59, v24
    v_cvt_pk_bf16_f32 v24, v24, v24
    v_and_b32 v55, 0xffff0000, v24
    v_max_f32 v57, v57, v55
    s_memrealtime s[12:13]
    s_nop 0
    v_max_f32_dpp v57, v57, v57 row_ror:1 row_mask:0xf bank_mask:0xf
    s_nop 1
    v_max_f32_dpp v57, v57, v57 row_ror:2 row_mask:0xf bank_mask:0xf
    s_nop 1
    v_max_f32_dpp v57, v57, v57 row_ror:4 row_mask:0xf bank_mask:0xf
    s_nop 1
    v_max_f32_dpp v57, v57, v57 row_ror:8 row_mask:0xf bank_mask:0xf
    v_mov_b32 v24, v57
    s_nop 1
    v_permlane16_swap_b32 v24, v57
    v_max_f32 v57, v57, v24
    v_mov_b32 v24, v57
    s_nop 1
    v_permlane32_swap_b32 v24, v57
    v_max_f32 v57, v57, v24
    s_mov_b32 s59, 0x3fb8aa3b
    s_waitcnt lgkmcnt(0)
    v_mul_f32 v25, s59, v57
    v_fma_f32 v48, v48, s59, -v25
    v_fma_f32 v49, v49, s59, -v25
    v_fma_f32 v50, v50, s59, -v25
    v_fma_f32 v51, v51, s59, -v25
    v_fma_f32 v52, v52, s59, -v25
    v_fma_f32 v53, v53, s59, -v25
    v_fma_f32 v54, v54, s59, -v25
    v_fma_f32 v55, v55, s59, -v25
    v_exp_f32 v48, v48
    v_exp_f32 v49, v49
    v_exp_f32 v50, v50
    v_exp_f32 v51, v51
    v_exp_f32 v52, v52
    v_exp_f32 v53, v53
    v_exp_f32 v54, v54
    v_exp_f32 v55, v55
    v_cvt_pk_bf16_f32 v8, v48, v48
    ds_write_b32 v56, v8 offset:0
    v_cvt_pk_bf16_f32 v9, v49, v49
    ds_write_b32 v56, v9 offset:256
    v_cvt_pk_bf16_f32 v10, v50, v50
    ds_write_b32 v56, v10 offset:512
    v_cvt_pk_bf16_f32 v11, v51, v51
    ds_write_b32 v56, v11 offset:768
    v_cvt_pk_bf16_f32 v12, v52, v52
    ds_write_b32 v56, v12 offset:1024
    v_cvt_pk_bf16_f32 v13, v53, v53
    ds_write_b32 v56, v13 offset:1280
    v_cvt_pk_bf16_f32 v14, v54, v54
    ds_write_b32 v56, v14 offset:1536
    v_cvt_pk_bf16_f32 v15, v55, v55
    ds_write_b32 v56, v15 offset:1792
    ds_read_b128 v[12:15], v3
    ds_read_b128 v[16:19], v3 offset:64
    v_add_f32 v48, v48, v49
    v_add_f32 v50, v50, v51
    v_add_f32 v52, v52, v53
    v_add_f32 v54, v54, v55
    v_add_f32 v48, v48, v50
    v_add_f32 v52, v52, v54
    v_add_f32 v58, v48, v52
    s_nop 1
    v_add_f32_dpp v58, v58, v58 row_ror:1 row_mask:0xf bank_mask:0xf
    s_nop 1
    v_add_f32_dpp v58, v58, v58 row_ror:2 row_mask:0xf bank_mask:0xf
    s_nop 1
    v_add_f32_dpp v58, v58, v58 row_ror:4 row_mask:0xf bank_mask:0xf
    s_nop 1
    v_add_f32_dpp v58, v58, v58 row_ror:8 row_mask:0xf bank_mask:0xf
    v_mov_b32 v24, v58
    s_nop 1
    v_permlane16_swap_b32 v24, v58
    v_add_f32 v58, v58, v24
    v_mov_b32 v24, v58
    s_nop 1
    v_permlane32_swap_b32 v24, v58
    v_add_f32 v58, v58, v24
    v_mov_b32 v26, v57
    v_mov_b32 v27, v58
    s_lshl_b32 s10, s3, 3
    v_mov_b32 v24, s10
    v_mov_b32 v25, 1
    ds_write_b64 v24, v[26:27] offset:64
    v_mov_b32 v24, 0
    v_mov_b32 v26, s12
    s_mov_b64 exec, 1
    ds_write_b32 v24, v26 offset:96
    ds_add_u32 v24, v25 offset:4
    s_mov_b64 exec, -1
    s_waitcnt lgkmcnt(0)
    v_and_b32 v32, v12, v4
    v_and_b32 v33, v12, v5
    v_and_b32 v34, v12, v6
    v_and_b32 v35, v12, v7
    v_and_b32 v36, v13, v4
    v_and_b32 v37, v13, v5
    v_and_b32 v38, v13, v6
    v_and_b32 v39, v13, v7
    v_and_b32 v40, v14, v4
    v_and_b32 v41, v14, v5
    v_and_b32 v42, v14, v6
    v_and_b32 v43, v14, v7
    v_and_b32 v44, v15, v4
    v_and_b32 v45, v15, v5
    v_and_b32 v46, v15, v6
    v_and_b32 v47, v15, v7
    v_mov_b32 v8, 0
    v_mov_b32 v9, 0
    v_mov_b32 v10, 0
    v_mov_b32 v11, 0
    v_add_u32 v3, 128, v3
    s_mov_b32 s11, 5
    s_cmp_lt_u32 s2, 128
    s_cselect_b32 s12, 3, 0
    s_cmp_eq_u32 s5, 0
    s_cselect_b32 s12, 0, s12
    s_cmp_eq_u32 s12, 0
    s_cbranch_scc1 L_vloop
    s_sub_u32 s11, s11, s12
L_vlight:
    s_waitcnt lgkmcnt(0)
    ds_read_b128 v[12:15], v3 offset:0
    s_waitcnt vmcnt(5)
    v_mfma_f32_16x16x32_bf16 v[8:11], v[32:35], v[64:67], v[8:11]
    buffer_load_dwordx4 v[96:99], v2, s[48:51], s58 offen nt
    v_and_b32 v48, v16, v4
    v_and_b32 v49, v16, v5
    v_and_b32 v50, v16, v6
    v_and_b32 v51, v16, v7
    s_waitcnt vmcnt(5)
    v_mfma_f32_16x16x32_bf16 v[8:11], v[36:39], v[68:71], v[8:11]
    buffer_load_dwordx4 v[100:103], v2, s[48:51], s58 offen offset:1024 nt
    v_and_b32 v52, v17, v4
    v_and_b32 v53, v17, v5
    v_and_b32 v54, v17, v6
    v_and_b32 v55, v17, v7
    s_waitcnt vmcnt(5)
    v_mfma_f32_16x16x32_bf16 v[8:11], v[40:43], v[72:75], v[8:11]
    buffer_load_dwordx4 v[104:107], v2, s[48:51], s58 offen offset:2048 nt
    v_and_b32 v56, v18, v4
    v_and_b32 v57, v18, v5
    v_and_b32 v58, v18, v6
    v_and_b32 v59, v18, v7
    s_waitcnt vmcnt(5)
    v_mfma_f32_16x16x32_bf16 v[8:11], v[44:47], v[76:79], v[8:11]
    buffer_load_dwordx4 v[108:111], v2, s[48:51], s58 offen offset:3072 nt
    s_add_u32 s58, s58, 16384
    v_and_b32 v60, v19, v4
    v_and_b32 v61, v19, v5
    v_and_b32 v62, v19, v6
    v_and_b32 v63, v19, v7
    s_waitcnt lgkmcnt(0)
    ds_read_b128 v[16:19], v3 offset:64
    s_waitcnt vmcnt(5)
    v_mfma_f32_16x16x32_bf16 v[8:11], v[48:51], v[80:83], v[8:11]
    buffer_load_dwordx4 v[112:115], v2, s[48:51], s58 offen nt
    v_and_b32 v32, v12, v4
    v_and_b32 v33, v12, v5
    v_and_b32 v34, v12, v6
    v_and_b32 v35, v12, v7
    s_waitcnt vmcnt(5)
    v_mfma_f32_16x16x32_bf16 v[8:11], v[52:55], v[84:87], v[8:11]
    buffer_load_dwordx4 v[116:119], v2, s[48:51], s58 offen offset:1024 nt
    v_and_b32 v36, v13, v4
    v_and_b32 v37, v13, v5
    v_and_b32 v38, v13, v6
    v_and_b32 v39, v13, v7
    s_waitcnt vmcnt(5)
    v_mfma_f32_16x16x32_bf16 v[8:11], v[56:59], v[88:91], v[8:11]
    buffer_load_dwordx4 v[120:123], v2, s[48:51], s58 offen offset:2048 nt
    v_and_b32 v40, v14, v4
    v_and_b32 v41, v14, v5
    v_and_b32 v42, v14, v6
    v_and_b32 v43, v14, v7
    s_waitcnt vmcnt(5)
    v_mfma_f32_16x16x32_bf16 v[8:11], v[60:63], v[92:95], v[8:11]
    buffer_load_dwordx4 v[124:127], v2, s[48:51], s58 offen offset:3072 nt
    s_add_u32 s58, s58, 16384
    v_and_b32 v44, v15, v4
    v_and_b32 v45, v15, v5
    v_and_b32 v46, v15, v6
    v_and_b32 v47, v15, v7
    s_waitcnt lgkmcnt(0)
    ds_read_b128 v[12:15], v3 offset:128
    s_waitcnt vmcnt(5)
    v_mfma_f32_16x16x32_bf16 v[8:11], v[32:35], v[96:99], v[8:11]
    buffer_load_dwordx4 v[64:67], v2, s[48:51], s58 offen nt
    v_and_b32 v48, v16, v4
    v_and_b32 v49, v16, v5
    v_and_b32 v50, v16, v6
    v_and_b32 v51, v16, v7
    s_waitcnt vmcnt(5)
    v_mfma_f32_16x16x32_bf16 v[8:11], v[36:39], v[100:103], v[8:11]
    buffer_load_dwordx4 v[68:71], v2, s[48:51], s58 offen offset:1024 nt
    v_and_b32 v52, v17, v4
    v_and_b32 v53, v17, v5
    v_and_b32 v54, v17, v6
    v_and_b32 v55, v17, v7
    s_waitcnt vmcnt(5)
    v_mfma_f32_16x16x32_bf16 v[8:11], v[40:43], v[104:107], v[8:11]
    buffer_load_dwordx4 v[72:75], v2, s[48:51], s58 offen offset:2048 nt
    v_and_b32 v56, v18, v4
    v_and_b32 v57, v18, v5
    v_and_b32 v58, v18, v6
    v_and_b32 v59, v18, v7
    s_waitcnt vmcnt(5)
    v_mfma_f32_16x16x32_bf16 v[8:11], v[44:47], v[108:111], v[8:11]
    buffer_load_dwordx4 v[76:79], v2, s[48:51], s58 offen offset:3072 nt
    s_add_u32 s58, s58, 16384
    v_and_b32 v60, v19, v4
    v_and_b32 v61, v19, v5
    v_and_b32 v62, v19, v6
    v_and_b32 v63, v19, v7
    s_waitcnt lgkmcnt(0)
    ds_read_b128 v[16:19], v3 offset:192
    s_waitcnt vmcnt(5)
    v_mfma_f32_16x16x32_bf16 v[8:11], v[48:51], v[112:115], v[8:11]
    buffer_load_dwordx4 v[80:83], v2, s[48:51], s58 offen nt
    v_and_b32 v32, v12, v4
    v_and_b32 v33, v12, v5
    v_and_b32 v34, v12, v6
    v_and_b32 v35, v12, v7
    s_waitcnt vmcnt(5)
    v_mfma_f32_16x16x32_bf16 v[8:11], v[52:55], v[116:119], v[8:11]
    buffer_load_dwordx4 v[84:87], v2, s[48:51], s58 offen offset:1024 nt
    v_and_b32 v36, v13, v4
    v_and_b32 v37, v13, v5
    v_and_b32 v38, v13, v6
    v_and_b32 v39, v13, v7
    s_waitcnt vmcnt(5)
    v_mfma_f32_16x16x32_bf16 v[8:11], v[56:59], v[120:123], v[8:11]
    buffer_load_dwordx4 v[88:91], v2, s[48:51], s58 offen offset:2048 nt
    v_and_b32 v40, v14, v4
    v_and_b32 v41, v14, v5
    v_and_b32 v42, v14, v6
    v_and_b32 v43, v14, v7
    s_waitcnt vmcnt(5)
    v_mfma_f32_16x16x32_bf16 v[8:11], v[60:63], v[124:127], v[8:11]
    buffer_load_dwordx4 v[92:95], v2, s[48:51], s58 offen offset:3072 nt
    s_add_u32 s58, s58, 16384
    v_and_b32 v44, v15, v4
    v_and_b32 v45, v15, v5
    v_and_b32 v46, v15, v6
    v_and_b32 v47, v15, v7
    v_add_u32 v3, 256, v3
    s_sub_u32 s12, s12, 1
    s_cmp_lg_u32 s12, 0
    s_cbranch_scc1 L_vlight
    s_cmp_eq_u32 s11, 0
    s_cbranch_scc1 L_vloopend
L_vloop:
    s_waitcnt lgkmcnt(0)
    ds_read_b128 v[12:15], v3 offset:0
    s_waitcnt vmcnt(7)
    v_mfma_f32_16x16x32_bf16 v[8:11], v[32:35], v[64:67], v[8:11]
    buffer_load_dwordx4 v[96:99], v2, s[48:51], s58 offen nt
    v_and_b32 v48, v16, v4
    v_and_b32 v49, v16, v5
    v_and_b32 v50, v16, v6
    v_and_b32 v51, v16, v7
    s_waitcnt vmcnt(7)
    v_mfma_f32_16x16x32_bf16 v[8:11], v[36:39], v[68:71], v[8:11]
    buffer_load_dwordx4 v[100:103], v2, s[48:51], s58 offen offset:1024 nt
    v_and_b32 v52, v17, v4
    v_and_b32 v53, v17, v5
    v_and_b32 v54, v17, v6
    v_and_b32 v55, v17, v7
    s_waitcnt vmcnt(7)
    v_mfma_f32_16x16x32_bf16 v[8:11], v[40:43], v[72:75], v[8:11]
    buffer_load_dwordx4 v[104:107], v2, s[48:51], s58 offen offset:2048 nt
    v_and_b32 v56, v18, v4
    v_and_b32 v57, v18, v5
    v_and_b32 v58, v18, v6
    v_and_b32 v59, v18, v7
    s_waitcnt vmcnt(7)
    v_mfma_f32_16x16x32_bf16 v[8:11], v[44:47], v[76:79], v[8:11]
    buffer_load_dwordx4 v[108:111], v2, s[48:51], s58 offen offset:3072 nt
    s_add_u32 s58, s58, 16384
    v_and_b32 v60, v19, v4
    v_and_b32 v61, v19, v5
    v_and_b32 v62, v19, v6
    v_and_b32 v63, v19, v7
    s_waitcnt lgkmcnt(0)
    ds_read_b128 v[16:19], v3 offset:64
    s_waitcnt vmcnt(7)
    v_mfma_f32_16x16x32_bf16 v[8:11], v[48:51], v[80:83], v[8:11]
    buffer_load_dwordx4 v[112:115], v2, s[48:51], s58 offen nt
    v_and_b32 v32, v12, v4
    v_and_b32 v33, v12, v5
    v_and_b32 v34, v12, v6
    v_and_b32 v35, v12, v7
    s_waitcnt vmcnt(7)
    v_mfma_f32_16x16x32_bf16 v[8:11], v[52:55], v[84:87], v[8:11]
    buffer_load_dwordx4 v[116:119], v2, s[48:51], s58 offen offset:1024 nt
    v_and_b32 v36, v13, v4
    v_and_b32 v37, v13, v5
    v_and_b32 v38, v13, v6
    v_and_b32 v39, v13, v7
    s_waitcnt vmcnt(7)
    v_mfma_f32_16x16x32_bf16 v[8:11], v[56:59], v[88:91], v[8:11]
    buffer_load_dwordx4 v[120:123], v2, s[48:51], s58 offen offset:2048 nt
    v_and_b32 v40, v14, v4
    v_and_b32 v41, v14, v5
    v_and_b32 v42, v14, v6
    v_and_b32 v43, v14, v7
    s_waitcnt vmcnt(7)
    v_mfma_f32_16x16x32_bf16 v[8:11], v[60:63], v[92:95], v[8:11]
    buffer_load_dwordx4 v[124:127], v2, s[48:51], s58 offen offset:3072 nt
    s_add_u32 s58, s58, 16384
    v_and_b32 v44, v15, v4
    v_and_b32 v45, v15, v5
    v_and_b32 v46, v15, v6
    v_and_b32 v47, v15, v7
    s_waitcnt lgkmcnt(0)
    ds_read_b128 v[12:15], v3 offset:128
    s_waitcnt vmcnt(7)
    v_mfma_f32_16x16x32_bf16 v[8:11], v[32:35], v[96:99], v[8:11]
    buffer_load_dwordx4 v[64:67], v2, s[48:51], s58 offen nt
    v_and_b32 v48, v16, v4
    v_and_b32 v49, v16, v5
    v_and_b32 v50, v16, v6
    v_and_b32 v51, v16, v7
    s_waitcnt vmcnt(7)
    v_mfma_f32_16x16x32_bf16 v[8:11], v[36:39], v[100:103], v[8:11]
    buffer_load_dwordx4 v[68:71], v2, s[48:51], s58 offen offset:1024 nt
    v_and_b32 v52, v17, v4
    v_and_b32 v53, v17, v5
    v_and_b32 v54, v17, v6
    v_and_b32 v55, v17, v7
    s_waitcnt vmcnt(7)
    v_mfma_f32_16x16x32_bf16 v[8:11], v[40:43], v[104:107], v[8:11]
    buffer_load_dwordx4 v[72:75], v2, s[48:51], s58 offen offset:2048 nt
    v_and_b32 v56, v18, v4
    v_and_b32 v57, v18, v5
    v_and_b32 v58, v18, v6
    v_and_b32 v59, v18, v7
    s_waitcnt vmcnt(7)
    v_mfma_f32_16x16x32_bf16 v[8:11], v[44:47], v[108:111], v[8:11]
    buffer_load_dwordx4 v[76:79], v2, s[48:51], s58 offen offset:3072 nt
    s_add_u32 s58, s58, 16384
    v_and_b32 v60, v19, v4
    v_and_b32 v61, v19, v5
    v_and_b32 v62, v19, v6
    v_and_b32 v63, v19, v7
    s_waitcnt lgkmcnt(0)
    ds_read_b128 v[16:19], v3 offset:192
    s_waitcnt vmcnt(7)
    v_mfma_f32_16x16x32_bf16 v[8:11], v[48:51], v[112:115], v[8:11]
    buffer_load_dwordx4 v[80:83], v2, s[48:51], s58 offen nt
    v_and_b32 v32, v12, v4
    v_and_b32 v33, v12, v5
    v_and_b32 v34, v12, v6
    v_and_b32 v35, v12, v7
    s_waitcnt vmcnt(7)
    v_mfma_f32_16x16x32_bf16 v[8:11], v[52:55], v[116:119], v[8:11]
    buffer_load_dwordx4 v[84:87], v2, s[48:51], s58 offen offset:1024 nt
    v_and_b32 v36, v13, v4
    v_and_b32 v37, v13, v5
    v_and_b32 v38, v13, v6
    v_and_b32 v39, v13, v7
    s_waitcnt vmcnt(7)
    v_mfma_f32_16x16x32_bf16 v[8:11], v[56:59], v[120:123], v[8:11]
    buffer_load_dwordx4 v[88:91], v2, s[48:51], s58 offen offset:2048 nt
    v_and_b32 v40, v14, v4
    v_and_b32 v41, v14, v5
    v_and_b32 v42, v14, v6
    v_and_b32 v43, v14, v7
    s_waitcnt vmcnt(7)
    v_mfma_f32_16x16x32_bf16 v[8:11], v[60:63], v[124:127], v[8:11]
    buffer_load_dwordx4 v[92:95], v2, s[48:51], s58 offen offset:3072 nt
    s_add_u32 s58, s58, 16384
    v_and_b32 v44, v15, v4
    v_and_b32 v45, v15, v5
    v_and_b32 v46, v15, v6
    v_and_b32 v47, v15, v7
    v_add_u32 v3, 256, v3
    s_sub_u32 s11, s11, 1
    s_cmp_lg_u32 s11, 0
    s_cbranch_scc1 L_vloop
L_vloopend:
    s_lshl_b32 s10, s3, 2
    v_mov_b32 v24, s10
    v_mov_b32 v26, 0
    s_mov_b32 s11, 131072
L_fwait:
    ds_read_b32 v25, v24 offset:32
    ds_read_b32 v27, v26 offset:48
    ds_read_b32 v28, v26 offset:28
    s_waitcnt lgkmcnt(0)
    v_cmp_ne_u32 vcc, -1, v25
    s_cbranch_vccnz L_fok
    s_sleep 2
    s_sub_u32 s11, s11, 1
    s_cmp_lg_u32 s11, 0
    s_cbranch_scc1 L_fwait
    v_mov_b32 v27, 0
L_fok:
    s_nop 0
    v_readfirstlane_b32 s12, v27
    v_readfirstlane_b32 s97, v28
    v_and_b32 v26, 1, v30
    v_lshlrev_b32 v26, 3, v26
    v_lshl_add_u32 v26, v31, 4, v26
    s_mul_i32 s10, s3, 272
    v_add_u32 v26, s10, v26
    s_sub_u32 s13, 32, s12
    s_lshl_b32 s13, s13, 14
    s_add_u32 s98, s98, s13
    s_add_u32 s12, s12, 32
    s_mov_b32 s13, 22
    s_mov_b32 s14, 20
    s_mov_b32 s15, 0x10000000
    s_cmp_ge_u32 s13, s12
    s_cselect_b32 s58, s15, s58
    s_cmp_lg_u32 s97, 4
    s_cbranch_scc1 L_vdyn
    v_mul_u32_u24 v188, 12, v0
    s_mul_i32 s10, s3, 11520
    s_add_u32 s10, s10, 32768
    v_add_u32 v188, s10, v188
    ds_read_b32 v128, v188 offset:0
    ds_read_b32 v129, v188 offset:4
    ds_read_b32 v130, v188 offset:8
    ds_read_b32 v132, v188 offset:768
    ds_read_b32 v133, v188 offset:772
    ds_read_b32 v134, v188 offset:776
    ds_read_b32 v136, v188 offset:1536
    ds_read_b32 v137, v188 offset:1540
    ds_read_b32 v138, v188 offset:1544
    s_waitcnt lgkmcnt(0)
    ds_read_b32 v140, v188 offset:2304
    ds_read_b32 v141, v188 offset:2308
    ds_read_b32 v142, v188 offset:2312
    ds_read_b32 v144, v188 offset:3072
    ds_read_b32 v145, v188 offset:3076
    ds_read_b32 v146, v188 offset:3080
    ds_read_b32 v148, v188 offset:3840
    ds_read_b32 v149, v188 offset:3844
    ds_read_b32 v150, v188 offset:3848
    s_waitcnt lgkmcnt(0)
    ds_read_b32 v152, v188 offset:4608
    ds_read_b32 v153, v188 offset:4612
    ds_read_b32 v154, v188 offset:4616
    ds_read_b32 v156, v188 offset:5376
    ds_read_b32 v157, v188 offset:5380
    ds_read_b32 v158, v188 offset:5384
    ds_read_b32 v160, v188 offset:6144
    ds_read_b32 v161, v188 offset:6148
    ds_read_b32 v162, v188 offset:6152
    s_waitcnt lgkmcnt(0)
    ds_read_b32 v164, v188 offset:6912
    ds_read_b32 v165, v188 offset:6916
    ds_read_b32 v166, v188 offset:6920
    ds_read_b32 v168, v188 offset:7680
    ds_read_b32 v169, v188 offset:7684
    ds_read_b32 v170, v188 offset:7688
    ds_read_b32 v172, v188 offset:8448
    ds_read_b32 v173, v188 offset:8452
    ds_read_b32 v174, v188 offset:8456
    s_waitcnt lgkmcnt(0)
    ds_read_b32 v176, v188 offset:9216
    ds_read_b32 v177, v188 offset:9220
    ds_read_b32 v178, v188 offset:9224
    ds_read_b32 v180, v188 offset:9984
    ds_read_b32 v181, v188 offset:9988
    ds_read_b32 v182, v188 offset:9992
    ds_read_b32 v184, v188 offset:10752
    ds_read_b32 v185, v188 offset:10756
    ds_read_b32 v186, v188 offset:10760
    s_waitcnt lgkmcnt(0)
    v_lshlrev_b32 v189, 4, v0
    v_cmp_gt_u32 vcc, 48, v0
    v_mov_b32 v190, 0x7ffffff0
    v_mov_b32 v191, 64.0
    v_cndmask_b32 v190, v190, v189, vcc
    v_cndmask_b32_e64 v191, v191, 0, vcc
    s_mul_i32 s11, s3, 1232
    s_add_u32 s11, s11, 10880
    v_add_u32 v195, 0, v0
    v_mul_u32_u24 v196, 1490, v195
    v_lshrrev_b32 v196, 16, v196
    v_mul_u32_u24 v192, 6, v195
    v_lshl_add_u32 v192, v196, 3, v192
    v_add_u32 v192, s11, v192
    v_add_u32 v195, 64, v0
    v_mul_u32_u24 v196, 1490, v195
    v_lshrrev_b32 v196, 16, v196
    v_mul_u32_u24 v193, 6, v195
    v_lshl_add_u32 v193, v196, 3, v193
    v_add_u32 v193, s11, v193
    v_add_u32 v195, 128, v0
    v_mul_u32_u24 v196, 1490, v195
    v_lshrrev_b32 v196, 16, v196
    v_mul_u32_u24 v194, 6, v195
    v_lshl_add_u32 v194, v196, 3, v194
    v_add_u32 v194, s11, v194
    s_mul_i32 s60, s3, 2816
    s_add_u32 s60, s60, 131072
    s_mul_i32 s67, s3, 6144
    s_lshl_b32 s10, s8, 7
    s_add_u32 s67, s67, s10
    s_add_u32 s67, s67, 167936
L_vdyn:
    s_cmp_lg_u32 s14, 32
    s_cbranch_scc1 L_vown
    s_nop 7
    v_mul_f32 v8, v8, v25
    v_mul_f32 v9, v9, v25
    v_mul_f32 v10, v10, v25
    v_mul_f32 v11, v11, v25
    v_mov_b32 v25, 1.0
L_vown:
    s_waitcnt lgkmcnt(0)
    ds_read_b128 v[12:15], v3 offset:0
    s_waitcnt vmcnt(7)
    v_mfma_f32_16x16x32_bf16 v[8:11], v[32:35], v[64:67], v[8:11]
    buffer_load_dwordx4 v[96:99], v2, s[48:51], s58 offen nt
    v_and_b32 v48, v16, v4
    v_and_b32 v49, v16, v5
    v_and_b32 v50, v16, v6
    v_and_b32 v51, v16, v7
    s_waitcnt vmcnt(7)
    v_mfma_f32_16x16x32_bf16 v[8:11], v[36:39], v[68:71], v[8:11]
    buffer_load_dwordx4 v[100:103], v2, s[48:51], s58 offen offset:1024 nt
    v_and_b32 v52, v17, v4
    v_and_b32 v53, v17, v5
    v_and_b32 v54, v17, v6
    v_and_b32 v55, v17, v7
    s_waitcnt vmcnt(7)
    v_mfma_f32_16x16x32_bf16 v[8:11], v[40:43], v[72:75], v[8:11]
    buffer_load_dwordx4 v[104:107], v2, s[48:51], s58 offen offset:2048 nt
    v_and_b32 v56, v18, v4
    v_and_b32 v57, v18, v5
    v_and_b32 v58, v18, v6
    v_and_b32 v59, v18, v7
    s_waitcnt vmcnt(7)
    v_mfma_f32_16x16x32_bf16 v[8:11], v[44:47], v[76:79], v[8:11]
    buffer_load_dwordx4 v[108:111], v2, s[48:51], s58 offen offset:3072 nt
    s_add_u32 s58, s58, 16384
    v_and_b32 v60, v19, v4
    v_and_b32 v61, v19, v5
    v_and_b32 v62, v19, v6
    v_and_b32 v63, v19, v7
    s_add_u32 s13, s13, 1
    s_cmp_eq_u32 s13, 32
    s_cselect_b32 s58, s98, s58
    s_cmp_ge_u32 s13, s12
    s_cselect_b32 s58, s15, s58
    s_add_u32 s14, s14, 1
    s_cmp_ge_u32 s14, s12
    s_cbranch_scc1 L_vend
    s_waitcnt lgkmcnt(0)
    ds_read_b128 v[16:19], v3 offset:64
    s_waitcnt vmcnt(7)
    v_mfma_f32_16x16x32_bf16 v[8:11], v[48:51], v[80:83], v[8:11]
    buffer_load_dwordx4 v[112:115], v2, s[48:51], s58 offen nt
    v_and_b32 v32, v12, v4
    v_and_b32 v33, v12, v5
    v_and_b32 v34, v12, v6
    v_and_b32 v35, v12, v7
    s_waitcnt vmcnt(7)
    v_mfma_f32_16x16x32_bf16 v[8:11], v[52:55], v[84:87], v[8:11]
    buffer_load_dwordx4 v[116:119], v2, s[48:51], s58 offen offset:1024 nt
    v_and_b32 v36, v13, v4
    v_and_b32 v37, v13, v5
    v_and_b32 v38, v13, v6
    v_and_b32 v39, v13, v7
    s_waitcnt vmcnt(7)
    v_mfma_f32_16x16x32_bf16 v[8:11], v[56:59], v[88:91], v[8:11]
    buffer_load_dwordx4 v[120:123], v2, s[48:51], s58 offen offset:2048 nt
    v_and_b32 v40, v14, v4
    v_and_b32 v41, v14, v5
    v_and_b32 v42, v14, v6
    v_and_b32 v43, v14, v7
    s_waitcnt vmcnt(7)
    v_mfma_f32_16x16x32_bf16 v[8:11], v[60:63], v[92:95], v[8:11]
    buffer_load_dwordx4 v[124:127], v2, s[48:51], s58 offen offset:3072 nt
    s_add_u32 s58, s58, 16384
    v_and_b32 v44, v15, v4
    v_and_b32 v45, v15, v5
    v_and_b32 v46, v15, v6
    v_and_b32 v47, v15, v7
    s_add_u32 s13, s13, 1
    s_cmp_eq_u32 s13, 32
    s_cselect_b32 s58, s98, s58
    s_cmp_ge_u32 s13, s12
    s_cselect_b32 s58, s15, s58
    s_add_u32 s14, s14, 1
    s_cmp_ge_u32 s14, s12
    s_cbranch_scc1 L_vend
    s_waitcnt lgkmcnt(0)
    ds_read_b128 v[12:15], v3 offset:128
    s_waitcnt vmcnt(7)
    v_mfma_f32_16x16x32_bf16 v[8:11], v[32:35], v[96:99], v[8:11]
    buffer_load_dwordx4 v[64:67], v2, s[48:51], s58 offen nt
    v_and_b32 v48, v16, v4
    v_and_b32 v49, v16, v5
    v_and_b32 v50, v16, v6
    v_and_b32 v51, v16, v7
    s_waitcnt vmcnt(7)
    v_mfma_f32_16x16x32_bf16 v[8:11], v[36:39], v[100:103], v[8:11]
    buffer_load_dwordx4 v[68:71], v2, s[48:51], s58 offen offset:1024 nt
    v_and_b32 v52, v17, v4
    v_and_b32 v53, v17, v5
    v_and_b32 v54, v17, v6
    v_and_b32 v55, v17, v7
    s_waitcnt vmcnt(7)
    v_mfma_f32_16x16x32_bf16 v[8:11], v[40:43], v[104:107], v[8:11]
    buffer_load_dwordx4 v[72:75], v2, s[48:51], s58 offen offset:2048 nt
    v_and_b32 v56, v18, v4
    v_and_b32 v57, v18, v5
    v_and_b32 v58, v18, v6
    v_and_b32 v59, v18, v7
    s_waitcnt vmcnt(7)
    v_mfma_f32_16x16x32_bf16 v[8:11], v[44:47], v[108:111], v[8:11]
    buffer_load_dwordx4 v[76:79], v2, s[48:51], s58 offen offset:3072 nt
    s_add_u32 s58, s58, 16384
    v_and_b32 v60, v19, v4
    v_and_b32 v61, v19, v5
    v_and_b32 v62, v19, v6
    v_and_b32 v63, v19, v7
    s_add_u32 s13, s13, 1
    s_cmp_eq_u32 s13, 32
    s_cselect_b32 s58, s98, s58
    s_cmp_ge_u32 s13, s12
    s_cselect_b32 s58, s15, s58
    s_add_u32 s14, s14, 1
    s_cmp_ge_u32 s14, s12
    s_cbranch_scc1 L_vend
    s_waitcnt lgkmcnt(0)
    ds_read_b128 v[16:19], v3 offset:192
    s_waitcnt vmcnt(7)
    v_mfma_f32_16x16x32_bf16 v[8:11], v[48:51], v[112:115], v[8:11]
    buffer_load_dwordx4 v[80:83], v2, s[48:51], s58 offen nt
    v_and_b32 v32, v12, v4
    v_and_b32 v33, v12, v5
    v_and_b32 v34, v12, v6
    v_and_b32 v35, v12, v7
    s_waitcnt vmcnt(7)
    v_mfma_f32_16x16x32_bf16 v[8:11], v[52:55], v[116:119], v[8:11]
    buffer_load_dwordx4 v[84:87], v2, s[48:51], s58 offen offset:1024 nt
    v_and_b32 v36, v13, v4
    v_and_b32 v37, v13, v5
    v_and_b32 v38, v13, v6
    v_and_b32 v39, v13, v7
    s_waitcnt vmcnt(7)
    v_mfma_f32_16x16x32_bf16 v[8:11], v[56:59], v[120:123], v[8:11]
    buffer_load_dwordx4 v[88:91], v2, s[48:51], s58 offen offset:2048 nt
    v_and_b32 v40, v14, v4
    v_and_b32 v41, v14, v5
    v_and_b32 v42, v14, v6
    v_and_b32 v43, v14, v7
    s_waitcnt vmcnt(7)
    v_mfma_f32_16x16x32_bf16 v[8:11], v[60:63], v[124:127], v[8:11]
    buffer_load_dwordx4 v[92:95], v2, s[48:51], s58 offen offset:3072 nt
    s_add_u32 s58, s58, 16384
    v_and_b32 v44, v15, v4
    v_and_b32 v45, v15, v5
    v_and_b32 v46, v15, v6
    v_and_b32 v47, v15, v7
    s_add_u32 s13, s13, 1
    s_cmp_eq_u32 s13, 32
    s_cselect_b32 s58, s98, s58
    s_cmp_ge_u32 s13, s12
    s_cselect_b32 s58, s15, s58
    s_add_u32 s14, s14, 1
    s_cmp_ge_u32 s14, s12
    s_cbranch_scc1 L_vend
    v_add_u32 v3, 256, v3
    s_branch L_vdyn
L_vend:
    v_pk_mul_f32 v[8:9], v[8:9], v[24:25] op_sel:[0,1]
    v_pk_mul_f32 v[10:11], v[10:11], v[24:25] op_sel:[0,1]
    v_cvt_pk_bf16_f32 v20, v8, v9
    v_cvt_pk_bf16_f32 v21, v10, v11
    ds_write_b64 v26, v[20:21] offset:25984
    v_lshlrev_b32 v32, 16, v20
    v_and_b32 v33, 0xffff0000, v20
    v_lshlrev_b32 v34, 16, v21
    v_and_b32 v35, 0xffff0000, v21
    v_pk_add_f32 v[8:9], v[8:9], v[32:33] neg_lo:[0,1] neg_hi:[0,1]
    v_pk_add_f32 v[10:11], v[10:11], v[34:35] neg_lo:[0,1] neg_hi:[0,1]
    v_cvt_pk_bf16_f32 v22, v8, v9
    v_cvt_pk_bf16_f32 v23, v10, v11
    ds_write_b64 v26, v[22:23] offset:27072
    s_waitcnt lgkmcnt(0)
    s_barrier
    s_cmp_lt_u32 s101, 43
    s_cbranch_scc1 L_ln2
    s_add_u32 s10, s3, s6
    s_cmp_lg_u32 s10, 0
    s_cbranch_scc1 L_done
    s_mov_b32 s44, s16
    s_mov_b32 s45, s17
    s_mov_b32 s46, 4096
    s_mov_b32 s47, 0x20000
    s_mov_b32 s48, s38
    s_mov_b32 s49, s39
    s_mov_b32 s50, 4096
    s_mov_b32 s51, 0x20000
    v_lshrrev_b32 v29, 2, v0
    v_and_b32 v2, 3, v0
    v_lshrrev_b32 v3, 1, v30
    v_and_b32 v4, 1, v30
    v_lshl_add_u32 v46, v4, 1, v3
    v_lshlrev_b32 v41, 4, v3
    s_and_b32 s12, s100, 3
    s_lshr_b32 s14, s100, 2
    s_lshl_b32 s14, s14, 4
    v_lshl_add_u32 v47, v2, 2, v46
    v_add_u32 v47, s14, v47
    v_lshrrev_b32 v48, 1, v47
    v_lshlrev_b32 v49, 2, v48
    v_lshlrev_b32 v48, 3, v48
    s_mul_i32 s10, s12, 12288
    s_add_u32 s66, s10, 14336
    s_add_u32 s10, s10, 8192
    s_lshl_b32 s13, s12, 10
    v_lshlrev_b32 v3, 1, v47
    buffer_load_ushort v7, v3, s[44:47], s13 offen
    s_mov_b32 s15, 131072
L_gchk:
    buffer_load_dwordx2 v[42:43], v48, s[52:55], s10 offen sc1
    buffer_load_dwordx2 v[44:45], v48, s[52:55], s66 offen sc1
    s_waitcnt vmcnt(0)
    v_bitop3_b32 v32, v43, v45, s56 bitop3:0x7e
    v_cmp_ne_u32 vcc, 0, v32
    s_cbranch_vccz L_gok
    s_sub_u32 s15, s15, 1
    s_cmp_lg_u32 s15, 0
    s_cbranch_scc1 L_gchk
L_gok:
    v_lshrrev_b32 v6, v41, v42
    v_lshlrev_b32 v6, 16, v6
    v_lshlrev_b32 v7, 16, v7
    v_lshrrev_b32 v28, v41, v44
    v_lshlrev_b32 v28, 16, v28
    v_mov_b32 v40, 0xff
    s_lshr_b32 s69, s56, 8
    s_lshr_b32 s70, s56, 16
    s_lshr_b32 s71, s56, 24
    v_and_b32 v4, 127, v47
    v_mul_u32_u24 v5, 0x5556, v4
    v_lshrrev_b32 v5, 16, v5
    v_add_lshl_u32 v4, v4, v5, 2
    s_lshr_b32 s63, s100, 5
    s_mul_i32 s63, s63, 704
    s_mul_i32 s10, s12, 2816
    s_add_u32 s63, s63, s10
    s_add_u32 s63, s63, 131072
    v_mul_u32_u24 v1, 8192, v29
    v_lshl_add_u32 v1, v2, 4, v1
    v_cmp_gt_u32 vcc, 11, v29
    v_mov_b32 v5, 0x7ffffff0
    s_nop 0
    v_cndmask_b32 v5, v5, v1, vcc
    s_mov_b64 s[64:65], vcc
    s_lshl_b32 s10, s100, 6
    s_add_u32 s60, s10, 786432
    s_add_u32 s61, s60, 131072
    s_add_u32 s62, s60, 262144
    s_lshl_b32 s67, s100, 7
    s_add_u32 s67, s67, 147456
    v_mov_b32 v50, 0
    s_mov_b32 s15, 131072
L_h2w:
    s_load_dword s68, s[42:43], s67 glc
    s_waitcnt lgkmcnt(0)
    s_cmp_eq_u32 s68, s56
    s_cbranch_scc1 L_h2wok
    s_sub_u32 s15, s15, 1
    s_cmp_lg_u32 s15, 0
    s_cbranch_scc1 L_h2w
L_h2wok:
    buffer_load_dword v20, v4, s[52:55], s63 offen sc1
    s_mov_b32 s15, 131072
L_t3poll:
    buffer_load_dwordx4 v[8:11], v1, s[52:55], s60 offen sc1
    buffer_load_dwordx4 v[12:15], v1, s[52:55], s61 offen sc1
    buffer_load_dwordx4 v[16:19], v5, s[52:55], s62 offen sc1
L_t3calc:
    s_waitcnt vmcnt(3)
    v_cvt_pk_bf16_f32 v21, v20, v20
    v_and_b32 v21, 0xffff0000, v21
    v_mul_f32 v21, v21, v6
    v_cvt_pk_bf16_f32 v21, v21, v21
    v_and_b32 v21, 0xffff0000, v21
    v_add_f32 v21, v21, v7
    v_cvt_pk_bf16_f32 v21, v21, v21
    v_and_b32 v21, 0xffff0000, v21
    s_waitcnt vmcnt(0)
    v_xor_b32 v36, s56, v16
    v_xor_b32 v37, s69, v17
    v_xor_b32 v38, s70, v18
    v_xor_b32 v39, s71, v19
    v_bitop3_b32 v32, v8, v12, s56 bitop3:0x7e
    v_bitop3_b32 v33, v9, v13, s69 bitop3:0x7e
    v_bitop3_b32 v34, v10, v14, s70 bitop3:0x7e
    v_bitop3_b32 v35, v11, v15, s71 bitop3:0x7e
    v_or3_b32 v36, v36, v37, v38
    v_or3_b32 v32, v32, v33, v34
    v_or_b32 v36, v36, v39
    v_cndmask_b32 v36, 0, v36, s[64:65]
    v_or_b32 v35, v35, v36
    v_bitop3_b32 v32, v32, v35, v40 bitop3:0xa8
    v_cmp_ne_u32 vcc, 0, v32
    s_cbranch_vccz L_t3ok
    s_mov_b64 exec, vcc
    s_sub_u32 s15, s15, 1
    s_cmp_lg_u32 s15, 0
    s_cbranch_scc1 L_t3poll
L_t3ok:
    s_mov_b64 exec, -1
    v_pk_add_f32 v[24:25], v[8:9], v[12:13]
    v_pk_add_f32 v[26:27], v[10:11], v[14:15]
    v_pk_add_f32 v[24:25], v[24:25], v[16:17]
    v_pk_add_f32 v[26:27], v[26:27], v[18:19]
    s_nop 0
    v_permlane32_swap_b32 v24, v25
    v_permlane32_swap_b32 v26, v27
    v_add_f32 v24, v24, v25
    v_add_f32 v26, v26, v27
    s_nop 1
    v_permlane16_swap_b32 v24, v26
    v_add_f32 v24, v24, v26
    s_nop 1
    v_add_f32_dpp v24, v24, v24 row_ror:4 row_mask:0xf bank_mask:0xf
    s_nop 1
    v_add_f32_dpp v24, v24, v24 row_ror:8 row_mask:0xf bank_mask:0xf
    v_cvt_pk_bf16_f32 v24, v24, v24
    v_and_b32 v24, 0xffff0000, v24
    v_mul_f32 v24, v24, v28
    v_cvt_pk_bf16_f32 v24, v24, v24
    v_and_b32 v24, 0xffff0000, v24
    v_add_f32 v24, v24, v21
    v_mov_b32 v25, v24
    s_nop 1
    v_permlane32_swap_b32 v24, v25
    v_cvt_pk_bf16_f32 v24, v24, v25
    v_mov_b32 v25, v24
    s_nop 1
    v_permlane16_swap_b32 v24, v25
    s_mov_b64 exec, 15
    buffer_store_dwordx2 v[24:25], v49, s[48:51], s13 offen sc0 sc1
L_done:
    s_endpgm
L_ln2:
    s_cmp_eq_u32 s97, 4
    s_cbranch_scc1 L_ln2go
    v_mul_u32_u24 v188, 12, v0
    s_mul_i32 s10, s3, 11520
    s_add_u32 s10, s10, 32768
    v_add_u32 v188, s10, v188
    ds_read_b32 v128, v188 offset:0
    ds_read_b32 v129, v188 offset:4
    ds_read_b32 v130, v188 offset:8
    ds_read_b32 v132, v188 offset:768
    ds_read_b32 v133, v188 offset:772
    ds_read_b32 v134, v188 offset:776
    ds_read_b32 v136, v188 offset:1536
    ds_read_b32 v137, v188 offset:1540
    ds_read_b32 v138, v188 offset:1544
    s_waitcnt lgkmcnt(0)
    ds_read_b32 v140, v188 offset:2304
    ds_read_b32 v141, v188 offset:2308
    ds_read_b32 v142, v188 offset:2312
    ds_read_b32 v144, v188 offset:3072
    ds_read_b32 v145, v188 offset:3076
    ds_read_b32 v146, v188 offset:3080
    ds_read_b32 v148, v188 offset:3840
    ds_read_b32 v149, v188 offset:3844
    ds_read_b32 v150, v188 offset:3848
    s_waitcnt lgkmcnt(0)
    ds_read_b32 v152, v188 offset:4608
    ds_read_b32 v153, v188 offset:4612
    ds_read_b32 v154, v188 offset:4616
    ds_read_b32 v156, v188 offset:5376
    ds_read_b32 v157, v188 offset:5380
    ds_read_b32 v158, v188 offset:5384
    ds_read_b32 v160, v188 offset:6144
    ds_read_b32 v161, v188 offset:6148
    ds_read_b32 v162, v188 offset:6152
    s_waitcnt lgkmcnt(0)
    ds_read_b32 v164, v188 offset:6912
    ds_read_b32 v165, v188 offset:6916
    ds_read_b32 v166, v188 offset:6920
    ds_read_b32 v168, v188 offset:7680
    ds_read_b32 v169, v188 offset:7684
    ds_read_b32 v170, v188 offset:7688
    ds_read_b32 v172, v188 offset:8448
    ds_read_b32 v173, v188 offset:8452
    ds_read_b32 v174, v188 offset:8456
    s_waitcnt lgkmcnt(0)
    ds_read_b32 v176, v188 offset:9216
    ds_read_b32 v177, v188 offset:9220
    ds_read_b32 v178, v188 offset:9224
    ds_read_b32 v180, v188 offset:9984
    ds_read_b32 v181, v188 offset:9988
    ds_read_b32 v182, v188 offset:9992
    ds_read_b32 v184, v188 offset:10752
    ds_read_b32 v185, v188 offset:10756
    ds_read_b32 v186, v188 offset:10760
    s_waitcnt lgkmcnt(0)
    v_lshlrev_b32 v189, 4, v0
    v_cmp_gt_u32 vcc, 48, v0
    v_mov_b32 v190, 0x7ffffff0
    v_mov_b32 v191, 64.0
    v_cndmask_b32 v190, v190, v189, vcc
    v_cndmask_b32_e64 v191, v191, 0, vcc
    s_mul_i32 s11, s3, 1232
    s_add_u32 s11, s11, 10880
    v_add_u32 v195, 0, v0
    v_mul_u32_u24 v196, 1490, v195
    v_lshrrev_b32 v196, 16, v196
    v_mul_u32_u24 v192, 6, v195
    v_lshl_add_u32 v192, v196, 3, v192
    v_add_u32 v192, s11, v192
    v_add_u32 v195, 64, v0
    v_mul_u32_u24 v196, 1490, v195
    v_lshrrev_b32 v196, 16, v196
    v_mul_u32_u24 v193, 6, v195
    v_lshl_add_u32 v193, v196, 3, v193
    v_add_u32 v193, s11, v193
    v_add_u32 v195, 128, v0
    v_mul_u32_u24 v196, 1490, v195
    v_lshrrev_b32 v196, 16, v196
    v_mul_u32_u24 v194, 6, v195
    v_lshl_add_u32 v194, v196, 3, v194
    v_add_u32 v194, s11, v194
    s_mul_i32 s60, s3, 2816
    s_add_u32 s60, s60, 131072
    s_mul_i32 s67, s3, 6144
    s_lshl_b32 s10, s8, 7
    s_add_u32 s67, s67, s10
    s_add_u32 s67, s67, 167936
L_ln2go:
    v_mov_b32 v50, 0
    s_mov_b32 s15, 131072
L_h1w:
    s_load_dword s68, s[42:43], s67 glc
    s_waitcnt lgkmcnt(0)
    s_cmp_ge_u32 s68, 64
    s_cbranch_scc1 L_h1wok
    s_sub_u32 s15, s15, 1
    s_cmp_lg_u32 s15, 0
    s_cbranch_scc1 L_h1w
L_h1wok:
    s_mov_b32 s15, 131072
L_xpoll:
    buffer_load_dwordx4 v[8:11], v189, s[52:55], s60 offen sc1
    buffer_load_dwordx4 v[12:15], v189, s[52:55], s60 offen offset:1024 sc1
    buffer_load_dwordx4 v[16:19], v190, s[52:55], s60 offen offset:2048 sc1
    s_waitcnt vmcnt(0)
L_xcalc:
    v_max_f32 v20, v19, v191
    v_min3_f32 v20, v11, v15, v20
    v_cmp_gt_f32 vcc, 64.0, v20
    s_cbranch_vccz L_xok
    s_mov_b64 exec, vcc
    s_sub_u32 s15, s15, 1
    s_cmp_lg_u32 s15, 0
    s_cbranch_scc1 L_xpoll
L_xok:
    s_mov_b64 exec, -1
    v_pk_fma_f32 v[32:33], v[128:129], v[8:9], v[140:141]
    v_pk_fma_f32 v[36:37], v[132:133], v[12:13], v[144:145]
    v_pk_fma_f32 v[40:41], v[136:137], v[16:17], v[148:149]
    v_fma_f32 v34, v130, v10, v142
    v_fma_f32 v38, v134, v14, v146
    v_fma_f32 v42, v138, v18, v150
    v_readfirstlane_b32 s61, v32
    s_nop 1
    v_sub_f32_e64 v22, 0, s61
    v_pk_fma_f32 v[32:33], v[152:153], v[22:23], v[32:33] op_sel_hi:[1,0,1]
    v_pk_fma_f32 v[36:37], v[156:157], v[22:23], v[36:37] op_sel_hi:[1,0,1]
    v_pk_fma_f32 v[40:41], v[160:161], v[22:23], v[40:41] op_sel_hi:[1,0,1]
    v_fma_f32 v34, v154, v22, v34
    v_fma_f32 v38, v158, v22, v38
    v_fma_f32 v42, v162, v22, v42
    v_pk_add_f32 v[24:25], v[32:33], v[36:37]
    v_pk_mul_f32 v[26:27], v[32:33], v[32:33]
    v_add_f32 v20, v34, v38
    v_mul_f32 v21, v34, v34
    v_pk_add_f32 v[24:25], v[24:25], v[40:41]
    v_pk_fma_f32 v[26:27], v[36:37], v[36:37], v[26:27]
    v_add_f32 v20, v20, v42
    v_fmac_f32 v21, v38, v38
    v_pk_fma_f32 v[26:27], v[40:41], v[40:41], v[26:27]
    v_fmac_f32 v21, v42, v42
    v_add_f32 v24, v24, v25
    v_add_f32 v26, v26, v27
    v_add_f32 v20, v20, v24
    v_add_f32 v21, v21, v26
    s_nop 0
    v_add_f32_dpp v20, v20, v20 row_ror:1 row_mask:0xf bank_mask:0xf
    v_add_f32_dpp v21, v21, v21 row_ror:1 row_mask:0xf bank_mask:0xf
    s_nop 0
    v_add_f32_dpp v20, v20, v20 row_ror:2 row_mask:0xf bank_mask:0xf
    v_add_f32_dpp v21, v21, v21 row_ror:2 row_mask:0xf bank_mask:0xf
    s_nop 0
    v_add_f32_dpp v20, v20, v20 row_ror:4 row_mask:0xf bank_mask:0xf
    v_add_f32_dpp v21, v21, v21 row_ror:4 row_mask:0xf bank_mask:0xf
    s_nop 0
    v_add_f32_dpp v20, v20, v20 row_ror:8 row_mask:0xf bank_mask:0xf
    v_add_f32_dpp v21, v21, v21 row_ror:8 row_mask:0xf bank_mask:0xf
    s_nop 1
    v_permlane16_swap_b32 v20, v21
    v_add_f32 v20, v20, v21
    v_mov_b32 v21, v20
    s_nop 1
    v_permlane32_swap_b32 v21, v20
    v_add_f32 v20, v20, v21
    v_mul_f32 v20, 0x3b000000, v20
    s_nop 0
    v_readlane_b32 s62, v20, 0
    v_readlane_b32 s63, v20, 16
    s_nop 0
    v_mov_b32 v20, s62
    v_mov_b32 v21, s63
    v_fma_f32 v21, -v20, v20, v21
    v_add_f32 v20, s61, v20
    v_max_f32 v21, 0, v21
    v_cvt_pk_bf16_f32 v22, v20, v21
    v_lshlrev_b32 v20, 16, v22
    v_and_b32 v23, 0xffff0000, v22
    v_add_f32 v23, 0x3727c5ac, v23
    v_sub_f32 v20, s61, v20
    v_cvt_pk_bf16_f32 v23, v23, v23
    v_and_b32 v23, 0xffff0000, v23
    v_sqrt_f32 v23, v23
    v_pk_add_f32 v[32:33], v[32:33], v[20:21] op_sel_hi:[1,0]
    v_pk_add_f32 v[36:37], v[36:37], v[20:21] op_sel_hi:[1,0]
    v_pk_add_f32 v[40:41], v[40:41], v[20:21] op_sel_hi:[1,0]
    v_add_f32 v34, v34, v20
    v_add_f32 v38, v38, v20
    v_add_f32 v42, v42, v20
    v_cvt_pk_bf16_f32 v23, v23, v23
    v_and_b32 v23, 0xffff0000, v23
    v_rcp_f32 v22, v23
    v_pk_mul_f32 v[32:33], v[32:33], v[164:165]
    v_pk_mul_f32 v[36:37], v[36:37], v[168:169]
    v_pk_mul_f32 v[40:41], v[40:41], v[172:173]
    v_mul_f32 v34, v34, v166
    v_mul_f32 v38, v38, v170
    v_mul_f32 v42, v42, v174
    v_pk_fma_f32 v[32:33], v[32:33], v[22:23], v[176:177] op_sel_hi:[1,0,1]
    v_pk_fma_f32 v[36:37], v[36:37], v[22:23], v[180:181] op_sel_hi:[1,0,1]
    v_pk_fma_f32 v[40:41], v[40:41], v[22:23], v[184:185] op_sel_hi:[1,0,1]
    v_fma_f32 v34, v34, v22, v178
    v_fma_f32 v38, v38, v22, v182
    v_fma_f32 v42, v42, v22, v186
    v_cvt_pk_bf16_f32 v24, v32, v33
    v_cvt_pk_bf16_f32 v44, v34, v34
    v_cvt_pk_bf16_f32 v25, v36, v37
    v_cvt_pk_bf16_f32 v45, v38, v38
    v_cvt_pk_bf16_f32 v26, v40, v41
    v_cvt_pk_bf16_f32 v46, v42, v42
    ds_write_b16 v192, v24
    ds_write_b16_d16_hi v192, v24 offset:2
    ds_write_b16 v192, v44 offset:4
    ds_write_b16 v193, v25
    ds_write_b16_d16_hi v193, v25 offset:2
    ds_write_b16 v193, v45 offset:4
    ds_write_b16 v194, v26
    ds_write_b16_d16_hi v194, v26 offset:2
    ds_write_b16 v194, v46 offset:4
    s_waitcnt lgkmcnt(0)
    s_barrier
    s_barrier
    s_endpgm
L_service:
    s_sub_u32 s7, s3, 4
    s_mov_b32 s62, 0x05040100
    s_mov_b32 s63, 0x07060302
    v_mov_b32 v4, 0
    v_mov_b32 v5, 0
    v_mov_b32 v6, 0
    v_mov_b32 v7, 0
    s_barrier
    s_waitcnt lgkmcnt(0)
    s_load_dword s56, s[42:43], 0
    s_mov_b32 s52, s42
    s_mov_b32 s53, s43
    s_mov_b32 s54, 2097152
    s_mov_b32 s55, 0x20000
    s_cmp_eq_u32 s99, 127
    s_cbranch_scc1 L_qwg
    s_cmp_ge_u32 s99, 48
    s_cbranch_scc1 L_rplain
    s_mov_b32 s13, s99
    s_setprio 3
    s_cmp_ge_u32 s13, 16
    s_cbranch_scc1 L_noclear
    s_lshl_b32 s10, s13, 2
    s_add_u32 s10, s10, s7
    s_mul_i32 s11, s10, 384
    s_add_u32 s11, s11, 167936
    s_mul_i32 s10, s10, 176
    s_add_u32 s10, s10, 131072
    v_lshlrev_b32 v2, 4, v0
    s_mov_b64 exec, 0x7ff
    buffer_store_dwordx4 v[4:7], v2, s[52:55], s10 offen sc1
    v_lshlrev_b32 v2, 7, v0
    s_mov_b64 exec, 7
    buffer_store_dword v4, v2, s[52:55], s11 offen sc1
    s_mov_b64 exec, -1
L_noclear:
    s_mov_b32 s44, s34
    s_mov_b32 s45, s35
    s_mov_b32 s46, 4096
    s_mov_b32 s47, 0x20000
    v_and_b32 v2, 3, v31
    v_lshlrev_b32 v2, 10, v2
    v_lshrrev_b32 v3, 2, v31
    v_lshl_add_u32 v2, v3, 6, v2
    v_lshl_add_u32 v2, v30, 4, v2
    s_lshl_b32 s10, s7, 8
    buffer_load_dwordx4 v[16:19], v2, s[44:47], s10 offen
    s_mov_b32 s44, s36
    s_mov_b32 s45, s37
    s_mov_b32 s46, 3145728
    s_mov_b32 s47, 0x20000
    v_mul_u32_u24 v2, 49152, v30
    v_lshl_add_u32 v2, v31, 3, v2
    s_mul_i32 s10, s7, 786432
    s_lshl_b32 s11, s13, 7
    s_add_u32 s10, s10, s11
    buffer_load_dwordx2 v[32:33], v2, s[44:47], s10 offen
    s_add_u32 s10, s10, 6144
    buffer_load_dwordx2 v[34:35], v2, s[44:47], s10 offen
    s_add_u32 s10, s10, 6144
    buffer_load_dwordx2 v[36:37], v2, s[44:47], s10 offen
    s_add_u32 s10, s10, 6144
    buffer_load_dwordx2 v[38:39], v2, s[44:47], s10 offen
    s_add_u32 s10, s10, 6144
    buffer_load_dwordx2 v[40:41], v2, s[44:47], s10 offen
    s_add_u32 s10, s10, 6144
    buffer_load_dwordx2 v[42:43], v2, s[44:47], s10 offen
    s_add_u32 s10, s10, 6144
    buffer_load_dwordx2 v[44:45], v2, s[44:47], s10 offen
    s_add_u32 s10, s10, 6144
    buffer_load_dwordx2 v[46:47], v2, s[44:47], s10 offen
    s_add_u32 s10, s10, 153600
    buffer_load_dwordx2 v[48:49], v2, s[44:47], s10 offen
    s_add_u32 s10, s10, 6144
    buffer_load_dwordx2 v[50:51], v2, s[44:47], s10 offen
    s_add_u32 s10, s10, 6144
    buffer_load_dwordx2 v[52:53], v2, s[44:47], s10 offen
    s_add_u32 s10, s10, 6144
    buffer_load_dwordx2 v[54:55], v2, s[44:47], s10 offen
    s_add_u32 s10, s10, 6144
    buffer_load_dwordx2 v[56:57], v2, s[44:47], s10 offen
    s_add_u32 s10, s10, 6144
    buffer_load_dwordx2 v[58:59], v2, s[44:47], s10 offen
    s_add_u32 s10, s10, 6144
    buffer_load_dwordx2 v[60:61], v2, s[44:47], s10 offen
    s_add_u32 s10, s10, 6144
    buffer_load_dwordx2 v[62:63], v2, s[44:47], s10 offen
    s_add_u32 s10, s10, 153600
    buffer_load_dwordx2 v[64:65], v2, s[44:47], s10 offen
    s_add_u32 s10, s10, 6144
    buffer_load_dwordx2 v[66:67], v2, s[44:47], s10 offen
    s_add_u32 s10, s10, 6144
    buffer_load_dwordx2 v[68:69], v2, s[44:47], s10 offen
    s_add_u32 s10, s10, 6144
    buffer_load_dwordx2 v[70:71], v2, s[44:47], s10 offen
    s_add_u32 s10, s10, 6144
    buffer_load_dwordx2 v[72:73], v2, s[44:47], s10 offen
    s_add_u32 s10, s10, 6144
    buffer_load_dwordx2 v[74:75], v2, s[44:47], s10 offen
    s_add_u32 s10, s10, 6144
    buffer_load_dwordx2 v[76:77], v2, s[44:47], s10 offen
    s_add_u32 s10, s10, 6144
    buffer_load_dwordx2 v[78:79], v2, s[44:47], s10 offen
    s_add_u32 s10, s10, 153600
    buffer_load_dwordx2 v[80:81], v2, s[44:47], s10 offen
    s_add_u32 s10, s10, 6144
    buffer_load_dwordx2 v[82:83], v2, s[44:47], s10 offen
    s_add_u32 s10, s10, 6144
    buffer_load_dwordx2 v[84:85], v2, s[44:47], s10 offen
    s_add_u32 s10, s10, 6144
    buffer_load_dwordx2 v[86:87], v2, s[44:47], s10 offen
    s_add_u32 s10, s10, 6144
    buffer_load_dwordx2 v[88:89], v2, s[44:47], s10 offen
    s_add_u32 s10, s10, 6144
    buffer_load_dwordx2 v[90:91], v2, s[44:47], s10 offen
    s_add_u32 s10, s10, 6144
    buffer_load_dwordx2 v[92:93], v2, s[44:47], s10 offen
    s_add_u32 s10, s10, 6144
    buffer_load_dwordx2 v[94:95], v2, s[44:47], s10 offen
    s_add_u32 s10, s10, 153600
    s_waitcnt lgkmcnt(0)
    s_and_b32 s10, s56, 0x80808080
    s_and_b32 s56, s56, 0x7f7f7f7f
    s_add_u32 s56, s56, 0x07050301
    s_xor_b32 s56, s56, s10
    s_waitcnt vmcnt(32)
    s_mov_b32 s59, 0xbfb8aa3b
    s_mov_b32 s58, 0xb2a57060
    v_lshlrev_b32 v96, 16, v16
    v_and_b32 v97, 0xffff0000, v16
    v_lshlrev_b32 v98, 16, v17
    v_and_b32 v99, 0xffff0000, v17
    v_lshlrev_b32 v100, 16, v18
    v_and_b32 v101, 0xffff0000, v18
    v_lshlrev_b32 v102, 16, v19
    v_and_b32 v103, 0xffff0000, v19
    v_mul_f32 v104, s59, v96
    v_mul_f32 v105, s59, v97
    v_mul_f32 v106, s59, v98
    v_mul_f32 v107, s59, v99
    v_mul_f32 v108, s59, v100
    v_mul_f32 v109, s59, v101
    v_mul_f32 v110, s59, v102
    v_mul_f32 v111, s59, v103
    v_fma_f32 v112, v96, s59, -v104
    v_fma_f32 v113, v97, s59, -v105
    v_fma_f32 v114, v98, s59, -v106
    v_fma_f32 v115, v99, s59, -v107
    v_fma_f32 v116, v100, s59, -v108
    v_fma_f32 v117, v101, s59, -v109
    v_fma_f32 v118, v102, s59, -v110
    v_fma_f32 v119, v103, s59, -v111
    v_fmac_f32 v112, s58, v96
    v_fmac_f32 v113, s58, v97
    v_fmac_f32 v114, s58, v98
    v_fmac_f32 v115, s58, v99
    v_fmac_f32 v116, s58, v100
    v_fmac_f32 v117, s58, v101
    v_fmac_f32 v118, s58, v102
    v_fmac_f32 v119, s58, v103
    v_exp_f32 v104, v104
    v_exp_f32 v105, v105
    v_exp_f32 v106, v106
    v_exp_f32 v107, v107
    v_exp_f32 v108, v108
    v_exp_f32 v109, v109
    v_exp_f32 v110, v110
    v_exp_f32 v111, v111
    v_mul_f32 v112, 0x3f317218, v112
    v_mul_f32 v113, 0x3f317218, v113
    v_mul_f32 v114, 0x3f317218, v114
    v_mul_f32 v115, 0x3f317218, v115
    v_mul_f32 v116, 0x3f317218, v116
    v_mul_f32 v117, 0x3f317218, v117
    v_mul_f32 v118, 0x3f317218, v118
    v_mul_f32 v119, 0x3f317218, v119
    v_min_f32 v104, 0x7cf0bdc2, v104
    v_min_f32 v105, 0x7cf0bdc2, v105
    v_min_f32 v106, 0x7cf0bdc2, v106
    v_min_f32 v107, 0x7cf0bdc2, v107
    v_min_f32 v108, 0x7cf0bdc2, v108
    v_min_f32 v109, 0x7cf0bdc2, v109
    v_min_f32 v110, 0x7cf0bdc2, v110
    v_min_f32 v111, 0x7cf0bdc2, v111
    v_fmac_f32 v104, v104, v112
    v_fmac_f32 v105, v105, v113
    v_fmac_f32 v106, v106, v114
    v_fmac_f32 v107, v107, v115
    v_fmac_f32 v108, v108, v116
    v_fmac_f32 v109, v109, v117
    v_fmac_f32 v110, v110, v118
    v_fmac_f32 v111, v111, v119
    v_add_f32 v104, 1.0, v104
    v_add_f32 v105, 1.0, v105
    v_add_f32 v106, 1.0, v106
    v_add_f32 v107, 1.0, v107
    v_add_f32 v108, 1.0, v108
    v_add_f32 v109, 1.0, v109
    v_add_f32 v110, 1.0, v110
    v_add_f32 v111, 1.0, v111
    v_rcp_f32 v120, v104
    v_rcp_f32 v121, v105
    v_rcp_f32 v122, v106
    v_rcp_f32 v123, v107
    v_rcp_f32 v124, v108
    v_rcp_f32 v125, v109
    v_rcp_f32 v126, v110
    v_rcp_f32 v127, v111
    v_mul_f32 v112, v96, v120
    v_mul_f32 v113, v97, v121
    v_mul_f32 v114, v98, v122
    v_mul_f32 v115, v99, v123
    v_mul_f32 v116, v100, v124
    v_mul_f32 v117, v101, v125
    v_mul_f32 v118, v102, v126
    v_mul_f32 v119, v103, v127
    v_fma_f32 v104, -v112, v104, v96
    v_fma_f32 v105, -v113, v105, v97
    v_fma_f32 v106, -v114, v106, v98
    v_fma_f32 v107, -v115, v107, v99
    v_fma_f32 v108, -v116, v108, v100
    v_fma_f32 v109, -v117, v109, v101
    v_fma_f32 v110, -v118, v110, v102
    v_fma_f32 v111, -v119, v111, v103
    v_fmac_f32 v112, v104, v120
    v_fmac_f32 v113, v105, v121
    v_fmac_f32 v114, v106, v122
    v_fmac_f32 v115, v107, v123
    v_fmac_f32 v116, v108, v124
    v_fmac_f32 v117, v109, v125
    v_fmac_f32 v118, v110, v126
    v_fmac_f32 v119, v111, v127
    v_cvt_pk_bf16_f32 v4, v112, v113
    v_cvt_pk_bf16_f32 v5, v114, v115
    v_cvt_pk_bf16_f32 v6, v116, v117
    v_cvt_pk_bf16_f32 v7, v118, v119
    v_mov_b32_dpp v8, v4 row_shl:4 row_mask:0xf bank_mask:0xf
    v_mov_b32_dpp v9, v5 row_shl:4 row_mask:0xf bank_mask:0xf
    v_mov_b32_dpp v10, v6 row_shl:4 row_mask:0xf bank_mask:0xf
    v_mov_b32_dpp v11, v7 row_shl:4 row_mask:0xf bank_mask:0xf
    v_mov_b32_dpp v12, v4 row_shl:8 row_mask:0xf bank_mask:0xf
    v_mov_b32_dpp v13, v5 row_shl:8 row_mask:0xf bank_mask:0xf
    v_mov_b32_dpp v14, v6 row_shl:8 row_mask:0xf bank_mask:0xf
    v_mov_b32_dpp v15, v7 row_shl:8 row_mask:0xf bank_mask:0xf
    v_mov_b32_dpp v16, v4 row_shl:12 row_mask:0xf bank_mask:0xf
    v_mov_b32_dpp v17, v5 row_shl:12 row_mask:0xf bank_mask:0xf
    v_mov_b32_dpp v18, v6 row_shl:12 row_mask:0xf bank_mask:0xf
    v_mov_b32_dpp v19, v7 row_shl:12 row_mask:0xf bank_mask:0xf
    s_waitcnt vmcnt(24)
    v_perm_b32 v96, v34, v32, s62
    v_perm_b32 v97, v38, v36, s62
    v_perm_b32 v98, v42, v40, s62
    v_perm_b32 v99, v46, v44, s62
    v_perm_b32 v100, v34, v32, s63
    v_perm_b32 v101, v38, v36, s63
    v_perm_b32 v102, v42, v40, s63
    v_perm_b32 v103, v46, v44, s63
    v_perm_b32 v104, v35, v33, s62
    v_perm_b32 v105, v39, v37, s62
    v_perm_b32 v106, v43, v41, s62
    v_perm_b32 v107, v47, v45, s62
    v_perm_b32 v108, v35, v33, s63
    v_perm_b32 v109, v39, v37, s63
    v_perm_b32 v110, v43, v41, s63
    v_perm_b32 v111, v47, v45, s63
    v_mfma_f32_16x16x32_bf16 v[112:115], v[4:7], v[96:99], 0
    v_mfma_f32_16x16x32_bf16 v[116:119], v[4:7], v[100:103], 0
    v_mfma_f32_16x16x32_bf16 v[120:123], v[4:7], v[104:107], 0
    v_mfma_f32_16x16x32_bf16 v[124:127], v[4:7], v[108:111], 0
    s_waitcnt vmcnt(16)
    v_perm_b32 v96, v50, v48, s62
    v_perm_b32 v97, v54, v52, s62
    v_perm_b32 v98, v58, v56, s62
    v_perm_b32 v99, v62, v60, s62
    v_perm_b32 v100, v50, v48, s63
    v_perm_b32 v101, v54, v52, s63
    v_perm_b32 v102, v58, v56, s63
    v_perm_b32 v103, v62, v60, s63
    v_perm_b32 v104, v51, v49, s62
    v_perm_b32 v105, v55, v53, s62
    v_perm_b32 v106, v59, v57, s62
    v_perm_b32 v107, v63, v61, s62
    v_perm_b32 v108, v51, v49, s63
    v_perm_b32 v109, v55, v53, s63
    v_perm_b32 v110, v59, v57, s63
    v_perm_b32 v111, v63, v61, s63
    v_mfma_f32_16x16x32_bf16 v[112:115], v[8:11], v[96:99], v[112:115]
    v_mfma_f32_16x16x32_bf16 v[116:119], v[8:11], v[100:103], v[116:119]
    v_mfma_f32_16x16x32_bf16 v[120:123], v[8:11], v[104:107], v[120:123]
    v_mfma_f32_16x16x32_bf16 v[124:127], v[8:11], v[108:111], v[124:127]
    s_waitcnt vmcnt(8)
    v_perm_b32 v96, v66, v64, s62
    v_perm_b32 v97, v70, v68, s62
    v_perm_b32 v98, v74, v72, s62
    v_perm_b32 v99, v78, v76, s62
    v_perm_b32 v100, v66, v64, s63
    v_perm_b32 v101, v70, v68, s63
    v_perm_b32 v102, v74, v72, s63
    v_perm_b32 v103, v78, v76, s63
    v_perm_b32 v104, v67, v65, s62
    v_perm_b32 v105, v71, v69, s62
    v_perm_b32 v106, v75, v73, s62
    v_perm_b32 v107, v79, v77, s62
    v_perm_b32 v108, v67, v65, s63
    v_perm_b32 v109, v71, v69, s63
    v_perm_b32 v110, v75, v73, s63
    v_perm_b32 v111, v79, v77, s63
    v_mfma_f32_16x16x32_bf16 v[112:115], v[12:15], v[96:99], v[112:115]
    v_mfma_f32_16x16x32_bf16 v[116:119], v[12:15], v[100:103], v[116:119]
    v_mfma_f32_16x16x32_bf16 v[120:123], v[12:15], v[104:107], v[120:123]
    v_mfma_f32_16x16x32_bf16 v[124:127], v[12:15], v[108:111], v[124:127]
    s_waitcnt vmcnt(0)
    v_perm_b32 v96, v82, v80, s62
    v_perm_b32 v97, v86, v84, s62
    v_perm_b32 v98, v90, v88, s62
    v_perm_b32 v99, v94, v92, s62
    v_perm_b32 v100, v82, v80, s63
    v_perm_b32 v101, v86, v84, s63
    v_perm_b32 v102, v90, v88, s63
    v_perm_b32 v103, v94, v92, s63
    v_perm_b32 v104, v83, v81, s62
    v_perm_b32 v105, v87, v85, s62
    v_perm_b32 v106, v91, v89, s62
    v_perm_b32 v107, v95, v93, s62
    v_perm_b32 v108, v83, v81, s63
    v_perm_b32 v109, v87, v85, s63
    v_perm_b32 v110, v91, v89, s63
    v_perm_b32 v111, v95, v93, s63
    v_mfma_f32_16x16x32_bf16 v[112:115], v[16:19], v[96:99], v[112:115]
    v_mfma_f32_16x16x32_bf16 v[116:119], v[16:19], v[100:103], v[116:119]
    v_mfma_f32_16x16x32_bf16 v[120:123], v[16:19], v[104:107], v[120:123]
    v_mfma_f32_16x16x32_bf16 v[124:127], v[16:19], v[108:111], v[124:127]
    s_lshl_b32 s10, s7, 10
    v_lshl_add_u32 v25, v31, 6, s10
    s_mov_b64 exec, 0xffff
    s_nop 1
    ds_write_b128 v25, v[112:115] offset:10880
    ds_write_b128 v25, v[116:119] offset:10896
    ds_write_b128 v25, v[120:123] offset:10912
    ds_write_b128 v25, v[124:127] offset:10928
    s_mov_b64 exec, 1
    v_mov_b32 v26, 0
    v_mov_b32 v27, 1
    ds_add_rtn_u32 v26, v26, v27 offset:0
    s_mov_b64 exec, -1
    v_lshlrev_b32 v25, 6, v31
    v_lshl_add_u32 v25, v30, 2, v25
    v_add_u32 v25, 10880, v25
    v_add_u32 v24, 2048, v25
    s_waitcnt lgkmcnt(0)
    v_readfirstlane_b32 s10, v26
    s_nop 0
    s_cmp_lg_u32 s10, 3
    s_cbranch_scc1 L_m1end
    ds_read2st64_b32 v[4:5], v25 offset0:0 offset1:4
    ds_read2st64_b32 v[12:13], v24 offset0:0 offset1:4
    v_add_u32 v25, 16, v25
    v_add_u32 v24, 16, v24
    ds_read2st64_b32 v[6:7], v25 offset0:0 offset1:4
    ds_read2st64_b32 v[14:15], v24 offset0:0 offset1:4
    v_add_u32 v25, 16, v25
    v_add_u32 v24, 16, v24
    ds_read2st64_b32 v[8:9], v25 offset0:0 offset1:4
    ds_read2st64_b32 v[16:17], v24 offset0:0 offset1:4
    v_add_u32 v25, 16, v25
    v_add_u32 v24, 16, v24
    ds_read2st64_b32 v[10:11], v25 offset0:0 offset1:4
    ds_read2st64_b32 v[18:19], v24 offset0:0 offset1:4
    v_mul_u32_u24 v2, 12288, v30
    v_lshl_add_u32 v2, v31, 4, v2
    s_lshl_b32 s10, s13, 8
    s_add_u32 s10, s10, 4096
    s_lshr_b32 s11, s13, 3
    s_waitcnt lgkmcnt(0)
    v_add_f32 v4, v4, v5
    v_add_f32 v12, v12, v13
    v_add_f32 v6, v6, v7
    v_add_f32 v14, v14, v15
    v_add_f32 v8, v8, v9
    v_add_f32 v16, v16, v17
    v_add_f32 v10, v10, v11
    v_add_f32 v18, v18, v19
    v_add_f32 v20, v4, v12
    v_add_f32 v21, v6, v14
    v_add_f32 v22, v8, v16
    v_add_f32 v23, v10, v18
    s_cmp_eq_u32 s11, 1
    s_cbranch_scc1 L_m1one
    s_cmp_lg_u32 s11, 4
    s_cbranch_scc1 L_m1st
L_m1one:
    v_cvt_pk_bf16_f32 v4, v20, v21
    v_cvt_pk_bf16_f32 v5, v22, v23
    v_lshlrev_b32 v20, 16, v4
    v_and_b32 v21, 0xffff0000, v4
    v_lshlrev_b32 v22, 16, v5
    v_and_b32 v23, 0xffff0000, v5
    v_add_f32 v20, 1.0, v20
    v_add_f32 v21, 1.0, v21
    v_add_f32 v22, 1.0, v22
    v_add_f32 v23, 1.0, v23
L_m1st:
    v_cvt_pk_bf16_f32 v4, v20, v21
    v_mov_b32 v5, s56
    v_cvt_pk_bf16_f32 v6, v22, v23
    v_mov_b32 v7, s56
    buffer_store_dwordx4 v[4:7], v2, s[52:55], s10 offen sc1
    s_waitcnt vmcnt(0)
L_m1end:
    v_mov_b32 v26, 0
    v_mov_b32 v27, 1
    s_mov_b64 exec, 1
    ds_add_u32 v26, v27 offset:20
    s_mov_b64 exec, -1
    s_setprio 0
    s_branch L_rjoin
L_rplain:
    s_waitcnt lgkmcnt(0)
    s_and_b32 s10, s56, 0x80808080
    s_and_b32 s56, s56, 0x7f7f7f7f
    s_add_u32 s56, s56, 0x07050301
    s_xor_b32 s56, s56, s10
L_rjoin:
    s_branch L_wo
L_qwg:
    s_setprio 3
    s_mov_b32 s48, s16
    s_mov_b32 s49, s17
    s_mov_b32 s50, 4096
    s_mov_b32 s51, 0x20000
    v_lshlrev_b32 v2, 4, v0
    v_lshlrev_b32 v3, 2, v0
    s_lshl_b32 s11, s7, 8
    buffer_load_dwordx4 v[32:35], v2, s[48:51], 0 offen offset:0
    buffer_load_dword v48, v3, s[48:51], s11 offen offset:0
    buffer_load_dwordx4 v[36:39], v2, s[48:51], 0 offen offset:1024
    buffer_load_dword v49, v3, s[48:51], s11 offen offset:1024
    buffer_load_dwordx4 v[40:43], v2, s[48:51], 0 offen offset:2048
    buffer_load_dword v50, v3, s[48:51], s11 offen offset:2048
    buffer_load_dwordx4 v[44:47], v2, s[48:51], 0 offen offset:3072
    buffer_load_dword v51, v3, s[48:51], s11 offen offset:3072
    v_lshlrev_b32 v1, 16, v30
    v_lshl_add_u32 v1, v31, 4, v1
    s_mov_b32 s44, s22
    s_mov_b32 s45, s23
    s_mov_b32 s46, 4194304
    s_mov_b32 s47, 0x20000
    s_lshl_b32 s57, s7, 20
    s_lshl_b32 s10, s4, 8
    s_add_u32 s57, s57, s10
    buffer_load_dwordx4 v[128:131], v1, s[44:47], s57 offen
    s_add_u32 s57, s57, 8192
    buffer_load_dwordx4 v[132:135], v1, s[44:47], s57 offen
    s_add_u32 s57, s57, 8192
    buffer_load_dwordx4 v[136:139], v1, s[44:47], s57 offen
    s_add_u32 s57, s57, 8192
    buffer_load_dwordx4 v[140:143], v1, s[44:47], s57 offen
    s_add_u32 s57, s57, 8192
    buffer_load_dwordx4 v[144:147], v1, s[44:47], s57 offen
    s_add_u32 s57, s57, 8192
    buffer_load_dwordx4 v[148:151], v1, s[44:47], s57 offen
    s_add_u32 s57, s57, 8192
    buffer_load_dwordx4 v[152:155], v1, s[44:47], s57 offen
    s_add_u32 s57, s57, 8192
    buffer_load_dwordx4 v[156:159], v1, s[44:47], s57 offen
    s_add_u32 s57, s57, 204800
    buffer_load_dwordx4 v[160:163], v1, s[44:47], s57 offen
    s_add_u32 s57, s57, 8192
    buffer_load_dwordx4 v[164:167], v1, s[44:47], s57 offen
    s_add_u32 s57, s57, 8192
    buffer_load_dwordx4 v[168:171], v1, s[44:47], s57 offen
    s_add_u32 s57, s57, 8192
    buffer_load_dwordx4 v[172:175], v1, s[44:47], s57 offen
    s_add_u32 s57, s57, 8192
    buffer_load_dwordx4 v[176:179], v1, s[44:47], s57 offen
    s_add_u32 s57, s57, 8192
    buffer_load_dwordx4 v[180:183], v1, s[44:47], s57 offen
    s_add_u32 s57, s57, 8192
    buffer_load_dwordx4 v[184:187], v1, s[44:47], s57 offen
    s_add_u32 s57, s57, 8192
    buffer_load_dwordx4 v[188:191], v1, s[44:47], s57 offen
    s_add_u32 s57, s57, 204800
    buffer_load_dwordx4 v[192:195], v1, s[44:47], s57 offen
    s_add_u32 s57, s57, 8192
    buffer_load_dwordx4 v[196:199], v1, s[44:47], s57 offen
    s_add_u32 s57, s57, 8192
    buffer_load_dwordx4 v[200:203], v1, s[44:47], s57 offen
    s_add_u32 s57, s57, 8192
    buffer_load_dwordx4 v[204:207], v1, s[44:47], s57 offen
    s_add_u32 s57, s57, 8192
    buffer_load_dwordx4 v[208:211], v1, s[44:47], s57 offen
    s_add_u32 s57, s57, 8192
    buffer_load_dwordx4 v[212:215], v1, s[44:47], s57 offen
    s_add_u32 s57, s57, 8192
    buffer_load_dwordx4 v[216:219], v1, s[44:47], s57 offen
    s_add_u32 s57, s57, 8192
    buffer_load_dwordx4 v[220:223], v1, s[44:47], s57 offen
    s_add_u32 s57, s57, 204800
    buffer_load_dwordx4 v[224:227], v1, s[44:47], s57 offen
    s_add_u32 s57, s57, 8192
    buffer_load_dwordx4 v[228:231], v1, s[44:47], s57 offen
    s_add_u32 s57, s57, 8192
    buffer_load_dwordx4 v[232:235], v1, s[44:47], s57 offen
    s_add_u32 s57, s57, 8192
    buffer_load_dwordx4 v[236:239], v1, s[44:47], s57 offen
    s_add_u32 s57, s57, 8192
    buffer_load_dwordx4 v[240:243], v1, s[44:47], s57 offen
    s_add_u32 s57, s57, 8192
    buffer_load_dwordx4 v[244:247], v1, s[44:47], s57 offen
    s_add_u32 s57, s57, 8192
    buffer_load_dwordx4 v[248:251], v1, s[44:47], s57 offen
    s_add_u32 s57, s57, 8192
    buffer_load_dwordx4 v[252:255], v1, s[44:47], s57 offen
    s_add_u32 s57, s57, 204800
    s_waitcnt lgkmcnt(0)
    s_and_b32 s10, s56, 0x80808080
    s_and_b32 s56, s56, 0x7f7f7f7f
    s_add_u32 s56, s56, 0x07050301
    s_xor_b32 s56, s56, s10
    s_waitcnt vmcnt(32)
    v_lshlrev_b32 v64, 16, v32
    v_and_b32 v65, 0xffff0000, v32
    v_lshlrev_b32 v66, 16, v33
    v_and_b32 v67, 0xffff0000, v33
    v_lshlrev_b32 v68, 16, v34
    v_and_b32 v69, 0xffff0000, v34
    v_lshlrev_b32 v70, 16, v35
    v_and_b32 v71, 0xffff0000, v35
    v_add_f32 v72, v64, v65
    v_add_f32 v73, v66, v67
    v_add_f32 v74, v68, v69
    v_add_f32 v75, v70, v71
    v_add_f32 v72, v72, v73
    v_add_f32 v74, v74, v75
    v_add_f32 v80, v72, v74
    s_nop 1
    v_add_f32_dpp v80, v80, v80 row_ror:1 row_mask:0xf bank_mask:0xf
    s_nop 1
    v_add_f32_dpp v80, v80, v80 row_ror:2 row_mask:0xf bank_mask:0xf
    s_nop 1
    v_add_f32_dpp v80, v80, v80 row_ror:4 row_mask:0xf bank_mask:0xf
    s_nop 1
    v_add_f32_dpp v80, v80, v80 row_ror:8 row_mask:0xf bank_mask:0xf
    v_mov_b32 v82, v80
    s_nop 1
    v_permlane16_swap_b32 v82, v80
    v_add_f32 v80, v80, v82
    v_mov_b32 v82, v80
    s_nop 1
    v_permlane32_swap_b32 v82, v80
    v_add_f32 v80, v80, v82
    v_mul_f32 v80, 0x3b000000, v80
    v_sub_f32 v72, v64, v80
    v_sub_f32 v73, v65, v80
    v_sub_f32 v74, v66, v80
    v_sub_f32 v75, v67, v80
    v_sub_f32 v76, v68, v80
    v_sub_f32 v77, v69, v80
    v_sub_f32 v78, v70, v80
    v_sub_f32 v79, v71, v80
    v_mul_f32 v81, v72, v72
    v_mul_f32 v82, v73, v73
    v_fmac_f32 v81, v74, v74
    v_fmac_f32 v82, v75, v75
    v_fmac_f32 v81, v76, v76
    v_fmac_f32 v82, v77, v77
    v_fmac_f32 v81, v78, v78
    v_fmac_f32 v82, v79, v79
    v_add_f32 v81, v81, v82
    s_nop 1
    v_add_f32_dpp v81, v81, v81 row_ror:1 row_mask:0xf bank_mask:0xf
    s_nop 1
    v_add_f32_dpp v81, v81, v81 row_ror:2 row_mask:0xf bank_mask:0xf
    s_nop 1
    v_add_f32_dpp v81, v81, v81 row_ror:4 row_mask:0xf bank_mask:0xf
    s_nop 1
    v_add_f32_dpp v81, v81, v81 row_ror:8 row_mask:0xf bank_mask:0xf
    v_mov_b32 v82, v81
    s_nop 1
    v_permlane16_swap_b32 v82, v81
    v_add_f32 v81, v81, v82
    v_mov_b32 v82, v81
    s_nop 1
    v_permlane32_swap_b32 v82, v81
    v_add_f32 v81, v81, v82
    v_cvt_pk_bf16_f32 v80, v80, v80
    v_and_b32 v80, 0xffff0000, v80
    v_mul_f32 v81, 0x3b000000, v81
    v_cvt_pk_bf16_f32 v81, v81, v81
    v_and_b32 v81, 0xffff0000, v81
    v_add_f32 v81, 0x3727c5ac, v81
    v_cvt_pk_bf16_f32 v81, v81, v81
    v_and_b32 v81, 0xffff0000, v81
    v_sqrt_f32 v81, v81
    s_nop 0
    v_cvt_pk_bf16_f32 v81, v81, v81
    v_and_b32 v81, 0xffff0000, v81
    v_rcp_f32 v81, v81
    v_lshlrev_b32 v52, 16, v48
    v_and_b32 v53, 0xffff0000, v48
    v_sub_f32 v52, v52, v80
    v_sub_f32 v53, v53, v80
    v_cvt_pk_bf16_f32 v82, v52, v53
    v_lshlrev_b32 v52, 16, v82
    v_and_b32 v53, 0xffff0000, v82
    v_mul_f32 v52, v52, v81
    v_mul_f32 v53, v53, v81
    v_cvt_pk_bf16_f32 v82, v52, v53
    v_lshlrev_b32 v52, 16, v82
    v_and_b32 v53, 0xffff0000, v82
    v_lshlrev_b32 v64, 16, v36
    v_and_b32 v65, 0xffff0000, v36
    v_lshlrev_b32 v66, 16, v37
    v_and_b32 v67, 0xffff0000, v37
    v_lshlrev_b32 v68, 16, v38
    v_and_b32 v69, 0xffff0000, v38
    v_lshlrev_b32 v70, 16, v39
    v_and_b32 v71, 0xffff0000, v39
    v_add_f32 v72, v64, v65
    v_add_f32 v73, v66, v67
    v_add_f32 v74, v68, v69
    v_add_f32 v75, v70, v71
    v_add_f32 v72, v72, v73
    v_add_f32 v74, v74, v75
    v_add_f32 v80, v72, v74
    s_nop 1
    v_add_f32_dpp v80, v80, v80 row_ror:1 row_mask:0xf bank_mask:0xf
    s_nop 1
    v_add_f32_dpp v80, v80, v80 row_ror:2 row_mask:0xf bank_mask:0xf
    s_nop 1
    v_add_f32_dpp v80, v80, v80 row_ror:4 row_mask:0xf bank_mask:0xf
    s_nop 1
    v_add_f32_dpp v80, v80, v80 row_ror:8 row_mask:0xf bank_mask:0xf
    v_mov_b32 v82, v80
    s_nop 1
    v_permlane16_swap_b32 v82, v80
    v_add_f32 v80, v80, v82
    v_mov_b32 v82, v80
    s_nop 1
    v_permlane32_swap_b32 v82, v80
    v_add_f32 v80, v80, v82
    v_mul_f32 v80, 0x3b000000, v80
    v_sub_f32 v72, v64, v80
    v_sub_f32 v73, v65, v80
    v_sub_f32 v74, v66, v80
    v_sub_f32 v75, v67, v80
    v_sub_f32 v76, v68, v80
    v_sub_f32 v77, v69, v80
    v_sub_f32 v78, v70, v80
    v_sub_f32 v79, v71, v80
    v_mul_f32 v81, v72, v72
    v_mul_f32 v82, v73, v73
    v_fmac_f32 v81, v74, v74
    v_fmac_f32 v82, v75, v75
    v_fmac_f32 v81, v76, v76
    v_fmac_f32 v82, v77, v77
    v_fmac_f32 v81, v78, v78
    v_fmac_f32 v82, v79, v79
    v_add_f32 v81, v81, v82
    s_nop 1
    v_add_f32_dpp v81, v81, v81 row_ror:1 row_mask:0xf bank_mask:0xf
    s_nop 1
    v_add_f32_dpp v81, v81, v81 row_ror:2 row_mask:0xf bank_mask:0xf
    s_nop 1
    v_add_f32_dpp v81, v81, v81 row_ror:4 row_mask:0xf bank_mask:0xf
    s_nop 1
    v_add_f32_dpp v81, v81, v81 row_ror:8 row_mask:0xf bank_mask:0xf
    v_mov_b32 v82, v81
    s_nop 1
    v_permlane16_swap_b32 v82, v81
    v_add_f32 v81, v81, v82
    v_mov_b32 v82, v81
    s_nop 1
    v_permlane32_swap_b32 v82, v81
    v_add_f32 v81, v81, v82
    v_cvt_pk_bf16_f32 v80, v80, v80
    v_and_b32 v80, 0xffff0000, v80
    v_mul_f32 v81, 0x3b000000, v81
    v_cvt_pk_bf16_f32 v81, v81, v81
    v_and_b32 v81, 0xffff0000, v81
    v_add_f32 v81, 0x3727c5ac, v81
    v_cvt_pk_bf16_f32 v81, v81, v81
    v_and_b32 v81, 0xffff0000, v81
    v_sqrt_f32 v81, v81
    s_nop 0
    v_cvt_pk_bf16_f32 v81, v81, v81
    v_and_b32 v81, 0xffff0000, v81
    v_rcp_f32 v81, v81
    v_lshlrev_b32 v54, 16, v49
    v_and_b32 v55, 0xffff0000, v49
    v_sub_f32 v54, v54, v80
    v_sub_f32 v55, v55, v80
    v_cvt_pk_bf16_f32 v82, v54, v55
    v_lshlrev_b32 v54, 16, v82
    v_and_b32 v55, 0xffff0000, v82
    v_mul_f32 v54, v54, v81
    v_mul_f32 v55, v55, v81
    v_cvt_pk_bf16_f32 v82, v54, v55
    v_lshlrev_b32 v54, 16, v82
    v_and_b32 v55, 0xffff0000, v82
    v_lshlrev_b32 v64, 16, v40
    v_and_b32 v65, 0xffff0000, v40
    v_lshlrev_b32 v66, 16, v41
    v_and_b32 v67, 0xffff0000, v41
    v_lshlrev_b32 v68, 16, v42
    v_and_b32 v69, 0xffff0000, v42
    v_lshlrev_b32 v70, 16, v43
    v_and_b32 v71, 0xffff0000, v43
    v_add_f32 v72, v64, v65
    v_add_f32 v73, v66, v67
    v_add_f32 v74, v68, v69
    v_add_f32 v75, v70, v71
    v_add_f32 v72, v72, v73
    v_add_f32 v74, v74, v75
    v_add_f32 v80, v72, v74
    s_nop 1
    v_add_f32_dpp v80, v80, v80 row_ror:1 row_mask:0xf bank_mask:0xf
    s_nop 1
    v_add_f32_dpp v80, v80, v80 row_ror:2 row_mask:0xf bank_mask:0xf
    s_nop 1
    v_add_f32_dpp v80, v80, v80 row_ror:4 row_mask:0xf bank_mask:0xf
    s_nop 1
    v_add_f32_dpp v80, v80, v80 row_ror:8 row_mask:0xf bank_mask:0xf
    v_mov_b32 v82, v80
    s_nop 1
    v_permlane16_swap_b32 v82, v80
    v_add_f32 v80, v80, v82
    v_mov_b32 v82, v80
    s_nop 1
    v_permlane32_swap_b32 v82, v80
    v_add_f32 v80, v80, v82
    v_mul_f32 v80, 0x3b000000, v80
    v_sub_f32 v72, v64, v80
    v_sub_f32 v73, v65, v80
    v_sub_f32 v74, v66, v80
    v_sub_f32 v75, v67, v80
    v_sub_f32 v76, v68, v80
    v_sub_f32 v77, v69, v80
    v_sub_f32 v78, v70, v80
    v_sub_f32 v79, v71, v80
    v_mul_f32 v81, v72, v72
    v_mul_f32 v82, v73, v73
    v_fmac_f32 v81, v74, v74
    v_fmac_f32 v82, v75, v75
    v_fmac_f32 v81, v76, v76
    v_fmac_f32 v82, v77, v77
    v_fmac_f32 v81, v78, v78
    v_fmac_f32 v82, v79, v79
    v_add_f32 v81, v81, v82
    s_nop 1
    v_add_f32_dpp v81, v81, v81 row_ror:1 row_mask:0xf bank_mask:0xf
    s_nop 1
    v_add_f32_dpp v81, v81, v81 row_ror:2 row_mask:0xf bank_mask:0xf
    s_nop 1
    v_add_f32_dpp v81, v81, v81 row_ror:4 row_mask:0xf bank_mask:0xf
    s_nop 1
    v_add_f32_dpp v81, v81, v81 row_ror:8 row_mask:0xf bank_mask:0xf
    v_mov_b32 v82, v81
    s_nop 1
    v_permlane16_swap_b32 v82, v81
    v_add_f32 v81, v81, v82
    v_mov_b32 v82, v81
    s_nop 1
    v_permlane32_swap_b32 v82, v81
    v_add_f32 v81, v81, v82
    v_cvt_pk_bf16_f32 v80, v80, v80
    v_and_b32 v80, 0xffff0000, v80
    v_mul_f32 v81, 0x3b000000, v81
    v_cvt_pk_bf16_f32 v81, v81, v81
    v_and_b32 v81, 0xffff0000, v81
    v_add_f32 v81, 0x3727c5ac, v81
    v_cvt_pk_bf16_f32 v81, v81, v81
    v_and_b32 v81, 0xffff0000, v81
    v_sqrt_f32 v81, v81
    s_nop 0
    v_cvt_pk_bf16_f32 v81, v81, v81
    v_and_b32 v81, 0xffff0000, v81
    v_rcp_f32 v81, v81
    v_lshlrev_b32 v56, 16, v50
    v_and_b32 v57, 0xffff0000, v50
    v_sub_f32 v56, v56, v80
    v_sub_f32 v57, v57, v80
    v_cvt_pk_bf16_f32 v82, v56, v57
    v_lshlrev_b32 v56, 16, v82
    v_and_b32 v57, 0xffff0000, v82
    v_mul_f32 v56, v56, v81
    v_mul_f32 v57, v57, v81
    v_cvt_pk_bf16_f32 v82, v56, v57
    v_lshlrev_b32 v56, 16, v82
    v_and_b32 v57, 0xffff0000, v82
    v_lshlrev_b32 v64, 16, v44
    v_and_b32 v65, 0xffff0000, v44
    v_lshlrev_b32 v66, 16, v45
    v_and_b32 v67, 0xffff0000, v45
    v_lshlrev_b32 v68, 16, v46
    v_and_b32 v69, 0xffff0000, v46
    v_lshlrev_b32 v70, 16, v47
    v_and_b32 v71, 0xffff0000, v47
    v_add_f32 v72, v64, v65
    v_add_f32 v73, v66, v67
    v_add_f32 v74, v68, v69
    v_add_f32 v75, v70, v71
    v_add_f32 v72, v72, v73
    v_add_f32 v74, v74, v75
    v_add_f32 v80, v72, v74
    s_nop 1
    v_add_f32_dpp v80, v80, v80 row_ror:1 row_mask:0xf bank_mask:0xf
    s_nop 1
    v_add_f32_dpp v80, v80, v80 row_ror:2 row_mask:0xf bank_mask:0xf
    s_nop 1
    v_add_f32_dpp v80, v80, v80 row_ror:4 row_mask:0xf bank_mask:0xf
    s_nop 1
    v_add_f32_dpp v80, v80, v80 row_ror:8 row_mask:0xf bank_mask:0xf
    v_mov_b32 v82, v80
    s_nop 1
    v_permlane16_swap_b32 v82, v80
    v_add_f32 v80, v80, v82
    v_mov_b32 v82, v80
    s_nop 1
    v_permlane32_swap_b32 v82, v80
    v_add_f32 v80, v80, v82
    v_mul_f32 v80, 0x3b000000, v80
    v_sub_f32 v72, v64, v80
    v_sub_f32 v73, v65, v80
    v_sub_f32 v74, v66, v80
    v_sub_f32 v75, v67, v80
    v_sub_f32 v76, v68, v80
    v_sub_f32 v77, v69, v80
    v_sub_f32 v78, v70, v80
    v_sub_f32 v79, v71, v80
    v_mul_f32 v81, v72, v72
    v_mul_f32 v82, v73, v73
    v_fmac_f32 v81, v74, v74
    v_fmac_f32 v82, v75, v75
    v_fmac_f32 v81, v76, v76
    v_fmac_f32 v82, v77, v77
    v_fmac_f32 v81, v78, v78
    v_fmac_f32 v82, v79, v79
    v_add_f32 v81, v81, v82
    s_nop 1
    v_add_f32_dpp v81, v81, v81 row_ror:1 row_mask:0xf bank_mask:0xf
    s_nop 1
    v_add_f32_dpp v81, v81, v81 row_ror:2 row_mask:0xf bank_mask:0xf
    s_nop 1
    v_add_f32_dpp v81, v81, v81 row_ror:4 row_mask:0xf bank_mask:0xf
    s_nop 1
    v_add_f32_dpp v81, v81, v81 row_ror:8 row_mask:0xf bank_mask:0xf
    v_mov_b32 v82, v81
    s_nop 1
    v_permlane16_swap_b32 v82, v81
    v_add_f32 v81, v81, v82
    v_mov_b32 v82, v81
    s_nop 1
    v_permlane32_swap_b32 v82, v81
    v_add_f32 v81, v81, v82
    v_cvt_pk_bf16_f32 v80, v80, v80
    v_and_b32 v80, 0xffff0000, v80
    v_mul_f32 v81, 0x3b000000, v81
    v_cvt_pk_bf16_f32 v81, v81, v81
    v_and_b32 v81, 0xffff0000, v81
    v_add_f32 v81, 0x3727c5ac, v81
    v_cvt_pk_bf16_f32 v81, v81, v81
    v_and_b32 v81, 0xffff0000, v81
    v_sqrt_f32 v81, v81
    s_nop 0
    v_cvt_pk_bf16_f32 v81, v81, v81
    v_and_b32 v81, 0xffff0000, v81
    v_rcp_f32 v81, v81
    v_lshlrev_b32 v58, 16, v51
    v_and_b32 v59, 0xffff0000, v51
    v_sub_f32 v58, v58, v80
    v_sub_f32 v59, v59, v80
    v_cvt_pk_bf16_f32 v82, v58, v59
    v_lshlrev_b32 v58, 16, v82
    v_and_b32 v59, 0xffff0000, v82
    v_mul_f32 v58, v58, v81
    v_mul_f32 v59, v59, v81
    v_cvt_pk_bf16_f32 v82, v58, v59
    v_lshlrev_b32 v58, 16, v82
    v_and_b32 v59, 0xffff0000, v82
    s_mul_i32 s11, s7, 1088
    s_add_u32 s11, s11, 19072
    v_add_u32 v28, s11, v3
    v_and_b32 v29, 3, v31
    v_mul_u32_u24 v29, 272, v29
    v_lshl_add_u32 v29, v30, 4, v29
    v_add_u32 v29, s11, v29
    v_lshlrev_b32 v2, 3, v0
    s_lshl_b32 s10, s7, 9
    s_add_u32 s64, s10, 4096
    s_add_u32 s65, s10, 16384
    s_add_u32 s66, s10, 28672
    s_add_u32 s67, s10, 40960
    s_waitcnt vmcnt(24)
    v_perm_b32 v96, v132, v128, s62
    v_perm_b32 v97, v140, v136, s62
    v_perm_b32 v98, v148, v144, s62
    v_perm_b32 v99, v156, v152, s62
    v_perm_b32 v100, v132, v128, s63
    v_perm_b32 v101, v140, v136, s63
    v_perm_b32 v102, v148, v144, s63
    v_perm_b32 v103, v156, v152, s63
    v_perm_b32 v104, v133, v129, s62
    v_perm_b32 v105, v141, v137, s62
    v_perm_b32 v106, v149, v145, s62
    v_perm_b32 v107, v157, v153, s62
    v_perm_b32 v108, v133, v129, s63
    v_perm_b32 v109, v141, v137, s63
    v_perm_b32 v110, v149, v145, s63
    v_perm_b32 v111, v157, v153, s63
    v_perm_b32 v112, v134, v130, s62
    v_perm_b32 v113, v142, v138, s62
    v_perm_b32 v114, v150, v146, s62
    v_perm_b32 v115, v158, v154, s62
    v_perm_b32 v116, v134, v130, s63
    v_perm_b32 v117, v142, v138, s63
    v_perm_b32 v118, v150, v146, s63
    v_perm_b32 v119, v158, v154, s63
    v_perm_b32 v120, v135, v131, s62
    v_perm_b32 v121, v143, v139, s62
    v_perm_b32 v122, v151, v147, s62
    v_perm_b32 v123, v159, v155, s62
    v_perm_b32 v124, v135, v131, s63
    v_perm_b32 v125, v143, v139, s63
    v_perm_b32 v126, v151, v147, s63
    v_perm_b32 v127, v159, v155, s63
    s_waitcnt vmcnt(16)
    v_perm_b32 v128, v164, v160, s62
    v_perm_b32 v129, v172, v168, s62
    v_perm_b32 v130, v180, v176, s62
    v_perm_b32 v131, v188, v184, s62
    v_perm_b32 v132, v164, v160, s63
    v_perm_b32 v133, v172, v168, s63
    v_perm_b32 v134, v180, v176, s63
    v_perm_b32 v135, v188, v184, s63
    v_perm_b32 v136, v165, v161, s62
    v_perm_b32 v137, v173, v169, s62
    v_perm_b32 v138, v181, v177, s62
    v_perm_b32 v139, v189, v185, s62
    v_perm_b32 v140, v165, v161, s63
    v_perm_b32 v141, v173, v169, s63
    v_perm_b32 v142, v181, v177, s63
    v_perm_b32 v143, v189, v185, s63
    v_perm_b32 v144, v166, v162, s62
    v_perm_b32 v145, v174, v170, s62
    v_perm_b32 v146, v182, v178, s62
    v_perm_b32 v147, v190, v186, s62
    v_perm_b32 v148, v166, v162, s63
    v_perm_b32 v149, v174, v170, s63
    v_perm_b32 v150, v182, v178, s63
    v_perm_b32 v151, v190, v186, s63
    v_perm_b32 v152, v167, v163, s62
    v_perm_b32 v153, v175, v171, s62
    v_perm_b32 v154, v183, v179, s62
    v_perm_b32 v155, v191, v187, s62
    v_perm_b32 v156, v167, v163, s63
    v_perm_b32 v157, v175, v171, s63
    v_perm_b32 v158, v183, v179, s63
    v_perm_b32 v159, v191, v187, s63
    s_waitcnt vmcnt(8)
    v_perm_b32 v160, v196, v192, s62
    v_perm_b32 v161, v204, v200, s62
    v_perm_b32 v162, v212, v208, s62
    v_perm_b32 v163, v220, v216, s62
    v_perm_b32 v164, v196, v192, s63
    v_perm_b32 v165, v204, v200, s63
    v_perm_b32 v166, v212, v208, s63
    v_perm_b32 v167, v220, v216, s63
    v_perm_b32 v168, v197, v193, s62
    v_perm_b32 v169, v205, v201, s62
    v_perm_b32 v170, v213, v209, s62
    v_perm_b32 v171, v221, v217, s62
    v_perm_b32 v172, v197, v193, s63
    v_perm_b32 v173, v205, v201, s63
    v_perm_b32 v174, v213, v209, s63
    v_perm_b32 v175, v221, v217, s63
    v_perm_b32 v176, v198, v194, s62
    v_perm_b32 v177, v206, v202, s62
    v_perm_b32 v178, v214, v210, s62
    v_perm_b32 v179, v222, v218, s62
    v_perm_b32 v180, v198, v194, s63
    v_perm_b32 v181, v206, v202, s63
    v_perm_b32 v182, v214, v210, s63
    v_perm_b32 v183, v222, v218, s63
    v_perm_b32 v184, v199, v195, s62
    v_perm_b32 v185, v207, v203, s62
    v_perm_b32 v186, v215, v211, s62
    v_perm_b32 v187, v223, v219, s62
    v_perm_b32 v188, v199, v195, s63
    v_perm_b32 v189, v207, v203, s63
    v_perm_b32 v190, v215, v211, s63
    v_perm_b32 v191, v223, v219, s63
    s_waitcnt vmcnt(0)
    v_perm_b32 v192, v228, v224, s62
    v_perm_b32 v193, v236, v232, s62
    v_perm_b32 v194, v244, v240, s62
    v_perm_b32 v195, v252, v248, s62
    v_perm_b32 v196, v228, v224, s63
    v_perm_b32 v197, v236, v232, s63
    v_perm_b32 v198, v244, v240, s63
    v_perm_b32 v199, v252, v248, s63
    v_perm_b32 v200, v229, v225, s62
    v_perm_b32 v201, v237, v233, s62
    v_perm_b32 v202, v245, v241, s62
    v_perm_b32 v203, v253, v249, s62
    v_perm_b32 v204, v229, v225, s63
    v_perm_b32 v205, v237, v233, s63
    v_perm_b32 v206, v245, v241, s63
    v_perm_b32 v207, v253, v249, s63
    v_perm_b32 v208, v230, v226, s62
    v_perm_b32 v209, v238, v234, s62
    v_perm_b32 v210, v246, v242, s62
    v_perm_b32 v211, v254, v250, s62
    v_perm_b32 v212, v230, v226, s63
    v_perm_b32 v213, v238, v234, s63
    v_perm_b32 v214, v246, v242, s63
    v_perm_b32 v215, v254, v250, s63
    v_perm_b32 v216, v231, v227, s62
    v_perm_b32 v217, v239, v235, s62
    v_perm_b32 v218, v247, v243, s62
    v_perm_b32 v219, v255, v251, s62
    v_perm_b32 v220, v231, v227, s63
    v_perm_b32 v221, v239, v235, s63
    v_perm_b32 v222, v247, v243, s63
    v_perm_b32 v223, v255, v251, s63
    s_mov_b32 s15, 131072
    s_add_u32 s10, s67, 4
    s_add_u32 s11, s10, 256
    s_add_u32 s13, s10, 2048
    s_add_u32 s14, s10, 2304
L_hs:
    s_load_dword s68, s[42:43], s10 glc
    s_load_dword s69, s[42:43], s11 glc
    s_load_dword s70, s[42:43], s13 glc
    s_load_dword s71, s[42:43], s14 glc
    s_waitcnt lgkmcnt(0)
    s_xor_b32 s68, s68, s56
    s_xor_b32 s69, s69, s56
    s_xor_b32 s70, s70, s56
    s_xor_b32 s71, s71, s56
    s_or_b32 s68, s68, s69
    s_or_b32 s70, s70, s71
    s_or_b32 s68, s68, s70
    s_cbranch_scc0 L_hpoll
    s_sleep 4
    s_sub_u32 s15, s15, 1
    s_cmp_lg_u32 s15, 0
    s_cbranch_scc1 L_hs
    s_mov_b32 s15, 2
L_hpoll:
    buffer_load_dwordx2 v[64:65], v2, s[52:55], s64 offen sc1
    buffer_load_dwordx2 v[66:67], v2, s[52:55], s64 offen offset:2048 sc1
    buffer_load_dwordx2 v[68:69], v2, s[52:55], s65 offen sc1
    buffer_load_dwordx2 v[70:71], v2, s[52:55], s65 offen offset:2048 sc1
    buffer_load_dwordx2 v[72:73], v2, s[52:55], s66 offen sc1
    buffer_load_dwordx2 v[74:75], v2, s[52:55], s66 offen offset:2048 sc1
    buffer_load_dwordx2 v[76:77], v2, s[52:55], s67 offen sc1
    buffer_load_dwordx2 v[78:79], v2, s[52:55], s67 offen offset:2048 sc1
    s_waitcnt vmcnt(0)
    v_bitop3_b32 v8, v65, v67, s56 bitop3:0x7e
    v_bitop3_b32 v9, v69, v71, s56 bitop3:0x7e
    v_bitop3_b32 v10, v73, v75, s56 bitop3:0x7e
    v_bitop3_b32 v11, v77, v79, s56 bitop3:0x7e
    v_or3_b32 v8, v8, v9, v10
    v_or_b32 v8, v8, v11
    v_cmp_ne_u32 vcc, 0, v8
    s_cbranch_vccz L_hok
    s_sleep 4
    s_sub_u32 s15, s15, 1
    s_cmp_lg_u32 s15, 0
    s_cbranch_scc1 L_hpoll
L_hok:
    v_lshlrev_b32 v4, 16, v66
    v_and_b32 v5, 0xffff0000, v66
    v_lshlrev_b32 v6, 16, v70
    v_and_b32 v7, 0xffff0000, v70
    v_lshlrev_b32 v8, 16, v74
    v_and_b32 v9, 0xffff0000, v74
    v_lshlrev_b32 v10, 16, v78
    v_and_b32 v11, 0xffff0000, v78
    v_mul_f32 v4, v4, v52
    v_mul_f32 v5, v5, v53
    v_mul_f32 v6, v6, v54
    v_mul_f32 v7, v7, v55
    v_mul_f32 v8, v8, v56
    v_mul_f32 v9, v9, v57
    v_mul_f32 v10, v10, v58
    v_mul_f32 v11, v11, v59
    v_cvt_pk_bf16_f32 v12, v4, v5
    v_cvt_pk_bf16_f32 v13, v6, v7
    v_cvt_pk_bf16_f32 v14, v8, v9
    v_cvt_pk_bf16_f32 v15, v10, v11
    v_lshlrev_b32 v4, 16, v12
    v_and_b32 v5, 0xffff0000, v12
    v_lshlrev_b32 v6, 16, v13
    v_and_b32 v7, 0xffff0000, v13
    v_lshlrev_b32 v8, 16, v14
    v_and_b32 v9, 0xffff0000, v14
    v_lshlrev_b32 v10, 16, v15
    v_and_b32 v11, 0xffff0000, v15
    v_lshlrev_b32 v16, 16, v64
    v_and_b32 v17, 0xffff0000, v64
    v_lshlrev_b32 v18, 16, v68
    v_and_b32 v19, 0xffff0000, v68
    v_lshlrev_b32 v20, 16, v72
    v_and_b32 v21, 0xffff0000, v72
    v_lshlrev_b32 v22, 16, v76
    v_and_b32 v23, 0xffff0000, v76
    v_add_f32 v4, v4, v16
    v_add_f32 v5, v5, v17
    v_add_f32 v6, v6, v18
    v_add_f32 v7, v7, v19
    v_add_f32 v8, v8, v20
    v_add_f32 v9, v9, v21
    v_add_f32 v10, v10, v22
    v_add_f32 v11, v11, v23
    v_cvt_pk_bf16_f32 v32, v4, v5
    ds_write_b32 v28, v32 offset:0
    v_cvt_pk_bf16_f32 v33, v6, v7
    ds_write_b32 v28, v33 offset:272
    v_cvt_pk_bf16_f32 v34, v8, v9
    ds_write_b32 v28, v34 offset:544
    v_cvt_pk_bf16_f32 v35, v10, v11
    ds_write_b32 v28, v35 offset:816
    ds_read_b128 v[12:15], v29 offset:0
    ds_read_b128 v[16:19], v29 offset:64
    ds_read_b128 v[20:23], v29 offset:128
    ds_read_b128 v[24:27], v29 offset:192
    s_lshl_b32 s10, s7, 11
    v_lshl_add_u32 v1, v31, 7, s10
    v_mov_b32 v4, 0
    v_mov_b32 v5, 1
    s_waitcnt lgkmcnt(3)
    v_mfma_f32_16x16x32_bf16 v[224:227], v[12:15], v[96:99], 0
    v_mfma_f32_16x16x32_bf16 v[228:231], v[12:15], v[100:103], 0
    v_mfma_f32_16x16x32_bf16 v[232:235], v[12:15], v[104:107], 0
    v_mfma_f32_16x16x32_bf16 v[236:239], v[12:15], v[108:111], 0
    v_mfma_f32_16x16x32_bf16 v[240:243], v[12:15], v[112:115], 0
    v_mfma_f32_16x16x32_bf16 v[244:247], v[12:15], v[116:119], 0
    v_mfma_f32_16x16x32_bf16 v[248:251], v[12:15], v[120:123], 0
    v_mfma_f32_16x16x32_bf16 v[252:255], v[12:15], v[124:127], 0
    s_waitcnt lgkmcnt(2)
    v_mfma_f32_16x16x32_bf16 v[224:227], v[16:19], v[128:131], v[224:227]
    v_mfma_f32_16x16x32_bf16 v[228:231], v[16:19], v[132:135], v[228:231]
    v_mfma_f32_16x16x32_bf16 v[232:235], v[16:19], v[136:139], v[232:235]
    v_mfma_f32_16x16x32_bf16 v[236:239], v[16:19], v[140:143], v[236:239]
    v_mfma_f32_16x16x32_bf16 v[240:243], v[16:19], v[144:147], v[240:243]
    v_mfma_f32_16x16x32_bf16 v[244:247], v[16:19], v[148:151], v[244:247]
    v_mfma_f32_16x16x32_bf16 v[248:251], v[16:19], v[152:155], v[248:251]
    v_mfma_f32_16x16x32_bf16 v[252:255], v[16:19], v[156:159], v[252:255]
    s_waitcnt lgkmcnt(1)
    v_mfma_f32_16x16x32_bf16 v[224:227], v[20:23], v[160:163], v[224:227]
    v_mfma_f32_16x16x32_bf16 v[228:231], v[20:23], v[164:167], v[228:231]
    v_mfma_f32_16x16x32_bf16 v[232:235], v[20:23], v[168:171], v[232:235]
    v_mfma_f32_16x16x32_bf16 v[236:239], v[20:23], v[172:175], v[236:239]
    v_mfma_f32_16x16x32_bf16 v[240:243], v[20:23], v[176:179], v[240:243]
    v_mfma_f32_16x16x32_bf16 v[244:247], v[20:23], v[180:183], v[244:247]
    v_mfma_f32_16x16x32_bf16 v[248:251], v[20:23], v[184:187], v[248:251]
    v_mfma_f32_16x16x32_bf16 v[252:255], v[20:23], v[188:191], v[252:255]
    s_waitcnt lgkmcnt(0)
    v_mfma_f32_16x16x32_bf16 v[224:227], v[24:27], v[192:195], v[224:227]
    v_mfma_f32_16x16x32_bf16 v[228:231], v[24:27], v[196:199], v[228:231]
    v_mfma_f32_16x16x32_bf16 v[232:235], v[24:27], v[200:203], v[232:235]
    v_mfma_f32_16x16x32_bf16 v[236:239], v[24:27], v[204:207], v[236:239]
    v_mfma_f32_16x16x32_bf16 v[240:243], v[24:27], v[208:211], v[240:243]
    v_mfma_f32_16x16x32_bf16 v[244:247], v[24:27], v[212:215], v[244:247]
    v_mfma_f32_16x16x32_bf16 v[248:251], v[24:27], v[216:219], v[248:251]
    v_mfma_f32_16x16x32_bf16 v[252:255], v[24:27], v[220:223], v[252:255]
    s_mov_b64 exec, 0xffff
    ds_write_b128 v1, v[224:227] offset:10880
    ds_write_b128 v1, v[228:231] offset:10896
    ds_write_b128 v1, v[232:235] offset:10912
    ds_write_b128 v1, v[236:239] offset:10928
    ds_write_b128 v1, v[240:243] offset:10944
    ds_write_b128 v1, v[244:247] offset:10960
    ds_write_b128 v1, v[248:251] offset:10976
    ds_write_b128 v1, v[252:255] offset:10992
    s_mov_b64 exec, 1
    ds_add_rtn_u32 v6, v4, v5 offset:16
    s_mov_b64 exec, -1
    v_lshlrev_b32 v1, 5, v0
    s_lshl_b32 s58, s4, 11
    s_add_u32 s58, s58, 196608
    s_waitcnt lgkmcnt(0)
    v_readfirstlane_b32 s10, v6
    s_nop 0
    s_cmp_lg_u32 s10, 3
    s_cbranch_scc1 L_qdone
    ds_read_b128 v[32:35], v1 offset:10880
    ds_read_b128 v[36:39], v1 offset:10896
    ds_read_b128 v[40:43], v1 offset:12928
    ds_read_b128 v[44:47], v1 offset:12944
    ds_read_b128 v[48:51], v1 offset:14976
    ds_read_b128 v[52:55], v1 offset:14992
    ds_read_b128 v[56:59], v1 offset:17024
    ds_read_b128 v[60:63], v1 offset:17040
    s_waitcnt lgkmcnt(0)
    v_add_f32 v32, v32, v40
    v_add_f32 v48, v48, v56
    v_add_f32 v33, v33, v41
    v_add_f32 v49, v49, v57
    v_add_f32 v34, v34, v42
    v_add_f32 v50, v50, v58
    v_add_f32 v35, v35, v43
    v_add_f32 v51, v51, v59
    v_add_f32 v36, v36, v44
    v_add_f32 v52, v52, v60
    v_add_f32 v37, v37, v45
    v_add_f32 v53, v53, v61
    v_add_f32 v38, v38, v46
    v_add_f32 v54, v54, v62
    v_add_f32 v39, v39, v47
    v_add_f32 v55, v55, v63
    v_add_f32 v32, v32, v48
    v_add_f32 v33, v33, v49
    v_add_f32 v34, v34, v50
    v_add_f32 v35, v35, v51
    v_add_f32 v36, v36, v52
    v_add_f32 v37, v37, v53
    v_add_f32 v38, v38, v54
    v_add_f32 v39, v39, v55
    v_cvt_pk_bf16_f32 v8, v32, v36
    v_mov_b32 v9, s56
    buffer_store_dwordx2 v[8:9], v2, s[52:55], s58 offen offset:0 sc1
    v_cvt_pk_bf16_f32 v10, v33, v37
    v_mov_b32 v11, s56
    buffer_store_dwordx2 v[10:11], v2, s[52:55], s58 offen offset:512 sc1
    v_cvt_pk_bf16_f32 v12, v34, v38
    v_mov_b32 v13, s56
    buffer_store_dwordx2 v[12:13], v2, s[52:55], s58 offen offset:1024 sc1
    v_cvt_pk_bf16_f32 v14, v35, v39
    v_mov_b32 v15, s56
    buffer_store_dwordx2 v[14:15], v2, s[52:55], s58 offen offset:1536 sc1
    s_waitcnt vmcnt(0)
L_qdone:
    v_mov_b32 v24, 0
    v_mov_b32 v25, 1
    s_mov_b64 exec, 1
    ds_add_u32 v24, v25 offset:20
    s_mov_b64 exec, -1
    s_setprio 0
L_wo:
    s_mov_b32 s44, s24
    s_mov_b32 s45, s25
    s_mov_b32 s46, 4194304
    s_mov_b32 s47, 0x20000
    v_lshlrev_b32 v1, 13, v30
    v_lshl_add_u32 v1, v31, 4, v1
    s_lshl_b32 s57, s4, 17
    s_lshl_b32 s10, s7, 8
    s_add_u32 s57, s57, s10
    buffer_load_dwordx4 v[128:131], v1, s[44:47], s57 offen
    s_add_u32 s57, s57, 1024
    buffer_load_dwordx4 v[132:135], v1, s[44:47], s57 offen
    s_add_u32 s57, s57, 1024
    buffer_load_dwordx4 v[136:139], v1, s[44:47], s57 offen
    s_add_u32 s57, s57, 1024
    buffer_load_dwordx4 v[140:143], v1, s[44:47], s57 offen
    s_add_u32 s57, s57, 1024
    s_waitcnt vmcnt(3)
    buffer_load_dwordx4 v[144:147], v1, s[44:47], s57 offen
    s_add_u32 s57, s57, 1024
    s_waitcnt vmcnt(3)
    buffer_load_dwordx4 v[148:151], v1, s[44:47], s57 offen
    s_add_u32 s57, s57, 1024
    s_waitcnt vmcnt(3)
    buffer_load_dwordx4 v[152:155], v1, s[44:47], s57 offen
    s_add_u32 s57, s57, 1024
    s_waitcnt vmcnt(3)
    buffer_load_dwordx4 v[156:159], v1, s[44:47], s57 offen
    s_add_u32 s57, s57, 25600
    s_waitcnt vmcnt(3)
    buffer_load_dwordx4 v[160:163], v1, s[44:47], s57 offen
    s_add_u32 s57, s57, 1024
    s_waitcnt vmcnt(3)
    buffer_load_dwordx4 v[164:167], v1, s[44:47], s57 offen
    s_add_u32 s57, s57, 1024
    s_waitcnt vmcnt(3)
    buffer_load_dwordx4 v[168:171], v1, s[44:47], s57 offen
    s_add_u32 s57, s57, 1024
    s_waitcnt vmcnt(3)
    buffer_load_dwordx4 v[172:175], v1, s[44:47], s57 offen
    s_add_u32 s57, s57, 1024
    v_perm_b32 v96, v132, v128, s62
    v_perm_b32 v97, v140, v136, s62
    v_perm_b32 v98, v148, v144, s62
    v_perm_b32 v99, v156, v152, s62
    v_perm_b32 v100, v132, v128, s63
    v_perm_b32 v101, v140, v136, s63
    v_perm_b32 v102, v148, v144, s63
    v_perm_b32 v103, v156, v152, s63
    v_perm_b32 v104, v133, v129, s62
    v_perm_b32 v105, v141, v137, s62
    v_perm_b32 v106, v149, v145, s62
    v_perm_b32 v107, v157, v153, s62
    v_perm_b32 v108, v133, v129, s63
    v_perm_b32 v109, v141, v137, s63
    v_perm_b32 v110, v149, v145, s63
    v_perm_b32 v111, v157, v153, s63
    v_perm_b32 v112, v134, v130, s62
    v_perm_b32 v113, v142, v138, s62
    v_perm_b32 v114, v150, v146, s62
    v_perm_b32 v115, v158, v154, s62
    v_perm_b32 v116, v134, v130, s63
    v_perm_b32 v117, v142, v138, s63
    v_perm_b32 v118, v150, v146, s63
    v_perm_b32 v119, v158, v154, s63
    v_perm_b32 v120, v135, v131, s62
    v_perm_b32 v121, v143, v139, s62
    v_perm_b32 v122, v151, v147, s62
    v_perm_b32 v123, v159, v155, s62
    v_perm_b32 v124, v135, v131, s63
    v_perm_b32 v125, v143, v139, s63
    v_perm_b32 v126, v151, v147, s63
    v_perm_b32 v127, v159, v155, s63
    s_waitcnt vmcnt(3)
    buffer_load_dwordx4 v[176:179], v1, s[44:47], s57 offen
    s_add_u32 s57, s57, 1024
    s_waitcnt vmcnt(3)
    buffer_load_dwordx4 v[180:183], v1, s[44:47], s57 offen
    s_add_u32 s57, s57, 1024
    s_waitcnt vmcnt(3)
    buffer_load_dwordx4 v[184:187], v1, s[44:47], s57 offen
    s_add_u32 s57, s57, 1024
    s_waitcnt vmcnt(3)
    buffer_load_dwordx4 v[188:191], v1, s[44:47], s57 offen
    s_add_u32 s57, s57, 25600
    s_waitcnt vmcnt(3)
    buffer_load_dwordx4 v[192:195], v1, s[44:47], s57 offen
    s_add_u32 s57, s57, 1024
    s_waitcnt vmcnt(3)
    buffer_load_dwordx4 v[196:199], v1, s[44:47], s57 offen
    s_add_u32 s57, s57, 1024
    s_waitcnt vmcnt(3)
    buffer_load_dwordx4 v[200:203], v1, s[44:47], s57 offen
    s_add_u32 s57, s57, 1024
    s_waitcnt vmcnt(3)
    buffer_load_dwordx4 v[204:207], v1, s[44:47], s57 offen
    s_add_u32 s57, s57, 1024
    v_perm_b32 v128, v164, v160, s62
    v_perm_b32 v129, v172, v168, s62
    v_perm_b32 v130, v180, v176, s62
    v_perm_b32 v131, v188, v184, s62
    v_perm_b32 v132, v164, v160, s63
    v_perm_b32 v133, v172, v168, s63
    v_perm_b32 v134, v180, v176, s63
    v_perm_b32 v135, v188, v184, s63
    v_perm_b32 v136, v165, v161, s62
    v_perm_b32 v137, v173, v169, s62
    v_perm_b32 v138, v181, v177, s62
    v_perm_b32 v139, v189, v185, s62
    v_perm_b32 v140, v165, v161, s63
    v_perm_b32 v141, v173, v169, s63
    v_perm_b32 v142, v181, v177, s63
    v_perm_b32 v143, v189, v185, s63
    v_perm_b32 v144, v166, v162, s62
    v_perm_b32 v145, v174, v170, s62
    v_perm_b32 v146, v182, v178, s62
    v_perm_b32 v147, v190, v186, s62
    v_perm_b32 v148, v166, v162, s63
    v_perm_b32 v149, v174, v170, s63
    v_perm_b32 v150, v182, v178, s63
    v_perm_b32 v151, v190, v186, s63
    v_perm_b32 v152, v167, v163, s62
    v_perm_b32 v153, v175, v171, s62
    v_perm_b32 v154, v183, v179, s62
    v_perm_b32 v155, v191, v187, s62
    v_perm_b32 v156, v167, v163, s63
    v_perm_b32 v157, v175, v171, s63
    v_perm_b32 v158, v183, v179, s63
    v_perm_b32 v159, v191, v187, s63
    s_waitcnt vmcnt(3)
    buffer_load_dwordx4 v[208:211], v1, s[44:47], s57 offen
    s_add_u32 s57, s57, 1024
    s_waitcnt vmcnt(3)
    buffer_load_dwordx4 v[212:215], v1, s[44:47], s57 offen
    s_add_u32 s57, s57, 1024
    s_waitcnt vmcnt(3)
    buffer_load_dwordx4 v[216:219], v1, s[44:47], s57 offen
    s_add_u32 s57, s57, 1024
    s_waitcnt vmcnt(3)
    buffer_load_dwordx4 v[220:223], v1, s[44:47], s57 offen
    s_add_u32 s57, s57, 25600
    s_waitcnt vmcnt(3)
    buffer_load_dwordx4 v[224:227], v1, s[44:47], s57 offen
    s_add_u32 s57, s57, 1024
    s_waitcnt vmcnt(3)
    buffer_load_dwordx4 v[228:231], v1, s[44:47], s57 offen
    s_add_u32 s57, s57, 1024
    s_waitcnt vmcnt(3)
    buffer_load_dwordx4 v[232:235], v1, s[44:47], s57 offen
    s_add_u32 s57, s57, 1024
    s_waitcnt vmcnt(3)
    buffer_load_dwordx4 v[236:239], v1, s[44:47], s57 offen
    s_add_u32 s57, s57, 1024
    v_perm_b32 v160, v196, v192, s62
    v_perm_b32 v161, v204, v200, s62
    v_perm_b32 v162, v212, v208, s62
    v_perm_b32 v163, v220, v216, s62
    v_perm_b32 v164, v196, v192, s63
    v_perm_b32 v165, v204, v200, s63
    v_perm_b32 v166, v212, v208, s63
    v_perm_b32 v167, v220, v216, s63
    v_perm_b32 v168, v197, v193, s62
    v_perm_b32 v169, v205, v201, s62
    v_perm_b32 v170, v213, v209, s62
    v_perm_b32 v171, v221, v217, s62
    v_perm_b32 v172, v197, v193, s63
    v_perm_b32 v173, v205, v201, s63
    v_perm_b32 v174, v213, v209, s63
    v_perm_b32 v175, v221, v217, s63
    v_perm_b32 v176, v198, v194, s62
    v_perm_b32 v177, v206, v202, s62
    v_perm_b32 v178, v214, v210, s62
    v_perm_b32 v179, v222, v218, s62
    v_perm_b32 v180, v198, v194, s63
    v_perm_b32 v181, v206, v202, s63
    v_perm_b32 v182, v214, v210, s63
    v_perm_b32 v183, v222, v218, s63
    v_perm_b32 v184, v199, v195, s62
    v_perm_b32 v185, v207, v203, s62
    v_perm_b32 v186, v215, v211, s62
    v_perm_b32 v187, v223, v219, s62
    v_perm_b32 v188, v199, v195, s63
    v_perm_b32 v189, v207, v203, s63
    v_perm_b32 v190, v215, v211, s63
    v_perm_b32 v191, v223, v219, s63
    s_waitcnt vmcnt(3)
    buffer_load_dwordx4 v[240:243], v1, s[44:47], s57 offen
    s_add_u32 s57, s57, 1024
    s_waitcnt vmcnt(3)
    buffer_load_dwordx4 v[244:247], v1, s[44:47], s57 offen
    s_add_u32 s57, s57, 1024
    s_waitcnt vmcnt(3)
    buffer_load_dwordx4 v[248:251], v1, s[44:47], s57 offen
    s_add_u32 s57, s57, 1024
    s_waitcnt vmcnt(3)
    buffer_load_dwordx4 v[252:255], v1, s[44:47], s57 offen
    s_add_u32 s57, s57, 25600
    s_waitcnt vmcnt(0)
    v_perm_b32 v192, v228, v224, s62
    v_perm_b32 v193, v236, v232, s62
    v_perm_b32 v194, v244, v240, s62
    v_perm_b32 v195, v252, v248, s62
    v_perm_b32 v196, v228, v224, s63
    v_perm_b32 v197, v236, v232, s63
    v_perm_b32 v198, v244, v240, s63
    v_perm_b32 v199, v252, v248, s63
    v_perm_b32 v200, v229, v225, s62
    v_perm_b32 v201, v237, v233, s62
    v_perm_b32 v202, v245, v241, s62
    v_perm_b32 v203, v253, v249, s62
    v_perm_b32 v204, v229, v225, s63
    v_perm_b32 v205, v237, v233, s63
    v_perm_b32 v206, v245, v241, s63
    v_perm_b32 v207, v253, v249, s63
    v_perm_b32 v208, v230, v226, s62
    v_perm_b32 v209, v238, v234, s62
    v_perm_b32 v210, v246, v242, s62
    v_perm_b32 v211, v254, v250, s62
    v_perm_b32 v212, v230, v226, s63
    v_perm_b32 v213, v238, v234, s63
    v_perm_b32 v214, v246, v242, s63
    v_perm_b32 v215, v254, v250, s63
    v_perm_b32 v216, v231, v227, s62
    v_perm_b32 v217, v239, v235, s62
    v_perm_b32 v218, v247, v243, s62
    v_perm_b32 v219, v255, v251, s62
    v_perm_b32 v220, v231, v227, s63
    v_perm_b32 v221, v239, v235, s63
    v_perm_b32 v222, v247, v243, s63
    v_perm_b32 v223, v255, v251, s63
L_wo3:
    s_cmp_lt_u32 s101, 43
    s_cselect_b32 s12, 1, 0
    s_cmp_eq_u32 s12, 0
    s_cbranch_scc1 L_noffn0
    v_mov_b32 v4, 0
    s_mov_b32 s15, 131072
L_kdone:
    ds_read_b32 v5, v4 offset:12
    s_waitcnt lgkmcnt(0)
    v_cmp_eq_u32 vcc, 4, v5
    s_cbranch_vccnz L_kdoneok
    s_sleep 4
    s_sub_u32 s15, s15, 1
    s_cmp_lg_u32 s15, 0
    s_cbranch_scc1 L_kdone
L_kdoneok:
    s_setprio 0
    s_mov_b32 s13, s101
    s_mov_b32 s44, s28
    s_mov_b32 s45, s29
    s_mov_b32 s46, 1409024
    s_mov_b32 s47, 0x20000
    s_mov_b32 s48, s30
    s_mov_b32 s49, s31
    s_mov_b32 s50, 1409024
    s_mov_b32 s51, 0x20000
    v_lshrrev_b32 v2, 2, v0
    v_mul_u32_u24 v2, 2752, v2
    v_and_b32 v3, 3, v0
    v_lshl_add_u32 v2, v3, 4, v2
    s_lshl_b32 s10, s13, 6
    s_mul_i32 s11, s7, 352256
    s_add_u32 s10, s10, s11
    s_lshl_b32 s14, s7, 13
    s_add_u32 s14, s14, 32768
    s_add_u32 m0, s14, 0
    s_nop 0
    buffer_load_dwordx4 v2, s[44:47], s10 offen lds
    s_add_u32 m0, s14, 32768
    s_nop 0
    buffer_load_dwordx4 v2, s[48:51], s10 offen lds
    s_add_u32 s10, s10, 44032
    s_waitcnt vmcnt(4)
    s_add_u32 m0, s14, 1024
    s_nop 0
    buffer_load_dwordx4 v2, s[44:47], s10 offen lds
    s_add_u32 m0, s14, 33792
    s_nop 0
    buffer_load_dwordx4 v2, s[48:51], s10 offen lds
    s_add_u32 s10, s10, 44032
    s_waitcnt vmcnt(4)
    s_add_u32 m0, s14, 2048
    s_nop 0
    buffer_load_dwordx4 v2, s[44:47], s10 offen lds
    s_add_u32 m0, s14, 34816
    s_nop 0
    buffer_load_dwordx4 v2, s[48:51], s10 offen lds
    s_add_u32 s10, s10, 44032
    s_waitcnt vmcnt(4)
    s_add_u32 m0, s14, 3072
    s_nop 0
    buffer_load_dwordx4 v2, s[44:47], s10 offen lds
    s_add_u32 m0, s14, 35840
    s_nop 0
    buffer_load_dwordx4 v2, s[48:51], s10 offen lds
    s_add_u32 s10, s10, 44032
    s_waitcnt vmcnt(4)
    s_add_u32 m0, s14, 4096
    s_nop 0
    buffer_load_dwordx4 v2, s[44:47], s10 offen lds
    s_add_u32 m0, s14, 36864
    s_nop 0
    buffer_load_dwordx4 v2, s[48:51], s10 offen lds
    s_add_u32 s10, s10, 44032
    s_waitcnt vmcnt(4)
    s_add_u32 m0, s14, 5120
    s_nop 0
    buffer_load_dwordx4 v2, s[44:47], s10 offen lds
    s_add_u32 m0, s14, 37888
    s_nop 0
    buffer_load_dwordx4 v2, s[48:51], s10 offen lds
    s_add_u32 s10, s10, 44032
    s_waitcnt vmcnt(4)
    s_add_u32 m0, s14, 6144
    s_nop 0
    buffer_load_dwordx4 v2, s[44:47], s10 offen lds
    s_add_u32 m0, s14, 38912
    s_nop 0
    buffer_load_dwordx4 v2, s[48:51], s10 offen lds
    s_add_u32 s10, s10, 44032
    s_waitcnt vmcnt(4)
    s_add_u32 m0, s14, 7168
    s_nop 0
    buffer_load_dwordx4 v2, s[44:47], s10 offen lds
    s_add_u32 m0, s14, 39936
    s_nop 0
    buffer_load_dwordx4 v2, s[48:51], s10 offen lds
    s_add_u32 s10, s10, 44032
    s_waitcnt vmcnt(4)
    s_mov_b32 s44, s32
    s_mov_b32 s45, s33
    s_mov_b32 s46, 1409024
    s_mov_b32 s47, 0x20000
    v_lshlrev_b32 v2, 10, v30
    v_lshl_add_u32 v2, v31, 4, v2
    s_lshl_b32 s10, s13, 15
    s_lshl_b32 s11, s7, 8
    s_add_u32 s10, s10, s11
    s_add_u32 s14, s14, 65536
    s_add_u32 m0, s14, 0
    s_nop 0
    buffer_load_dwordx4 v2, s[44:47], s10 offen lds
    s_add_u32 s10, s10, 4096
    s_waitcnt vmcnt(5)
    s_add_u32 m0, s14, 1024
    s_nop 0
    buffer_load_dwordx4 v2, s[44:47], s10 offen lds
    s_add_u32 s10, s10, 4096
    s_waitcnt vmcnt(5)
    s_add_u32 m0, s14, 2048
    s_nop 0
    buffer_load_dwordx4 v2, s[44:47], s10 offen lds
    s_add_u32 s10, s10, 4096
    s_waitcnt vmcnt(5)
    s_add_u32 m0, s14, 3072
    s_nop 0
    buffer_load_dwordx4 v2, s[44:47], s10 offen lds
    s_add_u32 s10, s10, 4096
    s_waitcnt vmcnt(5)
    s_add_u32 m0, s14, 4096
    s_nop 0
    buffer_load_dwordx4 v2, s[44:47], s10 offen lds
    s_add_u32 s10, s10, 4096
    s_waitcnt vmcnt(5)
    s_add_u32 m0, s14, 5120
    s_nop 0
    buffer_load_dwordx4 v2, s[44:47], s10 offen lds
    s_add_u32 s10, s10, 4096
    s_waitcnt vmcnt(5)
    s_add_u32 m0, s14, 6144
    s_nop 0
    buffer_load_dwordx4 v2, s[44:47], s10 offen lds
    s_add_u32 s10, s10, 4096
    s_waitcnt vmcnt(5)
    s_add_u32 m0, s14, 7168
    s_nop 0
    buffer_load_dwordx4 v2, s[44:47], s10 offen lds
    s_add_u32 s10, s10, 4096
    s_waitcnt vmcnt(5)
    s_waitcnt vmcnt(0)
    s_setprio 0
    v_mov_b32 v4, 0
    v_mov_b32 v5, 1
    s_mov_b64 exec, 1
    ds_add_u32 v4, v5 offset:8
    s_mov_b64 exec, -1
L_noffn0:
    s_cmp_lg_u32 s7, 0
    s_cbranch_scc1 L_noml
    v_mov_b32 v4, 0
    s_mov_b32 s15, 131072
L_mlw:
    ds_read_b32 v5, v4 offset:4
    s_waitcnt lgkmcnt(0)
    v_cmp_eq_u32 vcc, 4, v5
    s_cbranch_vccnz L_mlwok
    s_sleep 4
    s_sub_u32 s15, s15, 1
    s_cmp_lg_u32 s15, 0
    s_cbranch_scc1 L_mlw
L_mlwok:
    v_and_b32 v5, 3, v0
    v_lshlrev_b32 v6, 3, v5
    ds_read_b64 v[8:9], v6 offset:64
    s_mov_b32 s59, 0x3fb8aa3b
    s_waitcnt lgkmcnt(0)
    v_max_f32_dpp v10, v8, v8 quad_perm:[1,0,3,2] row_mask:0xf bank_mask:0xf
    s_nop 1
    v_max_f32_dpp v10, v10, v10 quad_perm:[2,3,0,1] row_mask:0xf bank_mask:0xf
    v_sub_f32 v11, v8, v10
    v_mul_f32 v11, s59, v11
    v_exp_f32 v11, v11
    s_nop 0
    v_mul_f32 v11, v11, v9
    s_nop 1
    v_add_f32_dpp v11, v11, v11 quad_perm:[1,0,3,2] row_mask:0xf bank_mask:0xf
    s_nop 1
    v_add_f32_dpp v11, v11, v11 quad_perm:[2,3,0,1] row_mask:0xf bank_mask:0xf
    ds_read_b32 v15, v4 offset:96
    s_mov_b32 s11, 0
    s_cmp_lt_u32 s99, 48
    s_cselect_b32 s11, 0, s11
    s_cmp_eq_u32 s99, 127
    s_cselect_b32 s11, 0, s11
    s_cmp_lt_u32 s101, 43
    s_cselect_b32 s11, 230, s11
    s_lshl_b32 s10, s100, 1
    s_add_u32 s10, s10, s6
    s_lshl_b32 s10, s10, 7
    s_add_u32 s10, s10, 65536
    v_mov_b32 v16, v10
    v_mov_b32 v17, s56
    v_mov_b32 v18, v11
    v_mov_b32 v19, s56
    v_mov_b32 v25, s56
    v_mov_b32 v26, s11
    v_mov_b32 v27, s56
    s_waitcnt lgkmcnt(0)
    v_mov_b32 v24, v15
    s_mov_b64 exec, 1
    buffer_store_dwordx4 v[16:19], v4, s[52:55], s10 offen sc1
    buffer_store_dwordx4 v[24:27], v4, s[52:55], s10 offen offset:16 sc1
    s_mov_b64 exec, -1
    s_xor_b32 s10, s10, 128
    s_mov_b32 s15, 131072
L_mlp:
    s_sleep 4
    s_load_dwordx8 s[64:71], s[42:43], s10 glc
    s_waitcnt lgkmcnt(0)
    s_xor_b32 s65, s65, s56
    s_xor_b32 s67, s67, s56
    s_xor_b32 s69, s69, s56
    s_xor_b32 s71, s71, s56
    s_or_b32 s65, s65, s67
    s_or_b32 s69, s69, s71
    s_or_b32 s65, s65, s69
    s_cbranch_scc0 L_mlpok
    s_sub_u32 s15, s15, 1
    s_cmp_lg_u32 s15, 0
    s_cbranch_scc1 L_mlp
L_mlpok:
    v_mov_b32 v20, s64
    v_mov_b32 v22, s66
    v_mov_b32 v224, s68
    v_mov_b32 v226, s70
    v_max_f32 v14, v10, v20
    v_sub_f32 v10, v10, v14
    v_sub_f32 v12, v20, v14
    v_sub_f32 v8, v8, v14
    v_mul_f32 v10, s59, v10
    v_mul_f32 v12, s59, v12
    v_mul_f32 v8, s59, v8
    v_exp_f32 v10, v10
    v_exp_f32 v12, v12
    v_exp_f32 v8, v8
    v_mul_f32 v10, v10, v11
    v_fmac_f32 v10, v12, v22
    v_rcp_f32 v10, v10
    s_nop 0
    v_mul_f32 v8, v8, v10
    v_sub_u32 v12, v224, v24
    v_sub_u32 v13, v226, v26
    v_cvt_f32_i32 v12, v12
    v_cvt_f32_i32 v13, v13
    v_mul_f32 v12, 0x3c14f209, v12
    v_mul_f32 v13, 0x3c14f209, v13
    v_add_f32 v12, v12, v13
    v_rndne_f32 v12, v12
    v_min_f32 v12, 0x41000000, v12
    v_max_f32 v12, 0xc1000000, v12
    v_cvt_i32_f32 v12, v12
    v_lshlrev_b32 v6, 2, v5
    v_readfirstlane_b32 s11, v12
    v_mul_u32_u24 v13, 2688, v30
    v_lshl_add_u32 v13, v31, 4, v13
    v_lshlrev_b32 v14, 9, v30
    v_lshl_add_u32 v14, v31, 4, v14
    s_lshl_b32 s10, s100, 11
    s_add_u32 s10, s10, 262144
    v_mov_b32 v15, 0xffff
    s_cmp_gt_i32 s11, 0
    s_cbranch_scc1 L_take
    ds_write_b32 v4, v12 offset:48
    ds_write_b32 v6, v8 offset:32
    s_or_b32 s64, s11, s6
    s_cbranch_scc0 L_mlend
    v_lshlrev_b32 v9, 2, v30
    ds_read_b32 v9, v9 offset:32
    ds_read_b128 v[16:19], v13 offset:1664
    ds_read_b128 v[20:23], v13 offset:1920
    s_waitcnt lgkmcnt(0)
    v_and_b32 v16, 0xffff0000, v16
    v_and_b32 v17, 0xffff0000, v17
    v_and_b32 v18, 0xffff0000, v18
    v_and_b32 v19, 0xffff0000, v19
    v_and_b32 v20, 0xffff0000, v20
    v_and_b32 v21, 0xffff0000, v21
    v_and_b32 v22, 0xffff0000, v22
    v_and_b32 v23, 0xffff0000, v23
    v_mul_f32 v16, v16, v9
    v_mul_f32 v17, v17, v9
    v_mul_f32 v18, v18, v9
    v_mul_f32 v19, v19, v9
    v_mul_f32 v20, v20, v9
    v_mul_f32 v21, v21, v9
    v_mul_f32 v22, v22, v9
    v_mul_f32 v23, v23, v9
    v_cvt_pk_bf16_f32 v16, v16, v16
    v_cvt_pk_bf16_f32 v17, v17, v17
    v_cvt_pk_bf16_f32 v18, v18, v18
    v_cvt_pk_bf16_f32 v19, v19, v19
    v_cvt_pk_bf16_f32 v20, v20, v20
    v_cvt_pk_bf16_f32 v21, v21, v21
    v_cvt_pk_bf16_f32 v22, v22, v22
    v_cvt_pk_bf16_f32 v23, v23, v23
    v_bfi_b32 v16, v15, s56, v16
    v_bfi_b32 v17, v15, s56, v17
    v_bfi_b32 v18, v15, s56, v18
    v_bfi_b32 v19, v15, s56, v19
    v_bfi_b32 v20, v15, s56, v20
    v_bfi_b32 v21, v15, s56, v21
    v_bfi_b32 v22, v15, s56, v22
    v_bfi_b32 v23, v15, s56, v23
    buffer_store_dwordx4 v[16:19], v14, s[52:55], s10 offen sc1
    buffer_store_dwordx4 v[20:23], v14, s[52:55], s10 offen offset:256 sc1
    s_branch L_mlend
L_take:
    s_mov_b32 s15, 131072
    s_add_u32 s64, s10, 2044
L_pxs:
    s_sleep 4
    s_load_dword s65, s[42:43], s64 glc
    s_waitcnt lgkmcnt(0)
    s_xor_b32 s65, s65, s56
    s_and_b32 s65, s65, 0xffff
    s_cbranch_scc0 L_pxgo
    s_sub_u32 s15, s15, 1
    s_cmp_lg_u32 s15, 0
    s_cbranch_scc1 L_pxs
    s_mov_b32 s15, 2
L_pxp:
    s_sleep 16
L_pxgo:
    buffer_load_dwordx4 v[16:19], v14, s[52:55], s10 offen sc1
    buffer_load_dwordx4 v[20:23], v14, s[52:55], s10 offen offset:256 sc1
    s_waitcnt vmcnt(0)
    v_bitop3_b32 v24, v16, v17, s56 bitop3:0x7e
    v_bitop3_b32 v25, v18, v19, s56 bitop3:0x7e
    v_bitop3_b32 v26, v20, v21, s56 bitop3:0x7e
    v_bitop3_b32 v27, v22, v23, s56 bitop3:0x7e
    v_or3_b32 v24, v24, v25, v26
    v_bitop3_b32 v24, v24, v27, v15 bitop3:0xa8
    v_cmp_ne_u32 vcc, 0, v24
    s_cbranch_vccz L_pxok
    s_sub_u32 s15, s15, 1
    s_cmp_lg_u32 s15, 0
    s_cbranch_scc1 L_pxp
L_pxok:
    s_mov_b32 s10, 0x03020302
    v_perm_b32 v16, v16, v16, s10
    v_perm_b32 v17, v17, v17, s10
    v_perm_b32 v18, v18, v18, s10
    v_perm_b32 v19, v19, v19, s10
    v_perm_b32 v20, v20, v20, s10
    v_perm_b32 v21, v21, v21, s10
    v_perm_b32 v22, v22, v22, s10
    v_perm_b32 v23, v23, v23, s10
    s_lshl_b32 s10, s11, 6
    v_add_u32 v13, s10, v13
    v_lshrrev_b32 v9, 2, v31
    v_add_u32 v9, s11, v9
    v_cmp_le_u32 vcc, 8, v9
    s_nop 0
    s_and_b64 exec, exec, vcc
    ds_write_b128 v13, v[16:19] offset:1664
    s_mov_b64 exec, -1
    v_cmp_le_u32 vcc, 4, v9
    s_nop 0
    s_and_b64 exec, exec, vcc
    ds_write_b128 v13, v[20:23] offset:1920
    s_mov_b64 exec, -1
    ds_write_b32 v4, v12 offset:48
    ds_write_b32 v6, v8 offset:32
L_mlend:
    s_waitcnt vmcnt(0) lgkmcnt(0)
L_noml:
    s_cmp_eq_u32 s12, 0
    s_cbranch_scc1 L_noffn
    v_lshlrev_b32 v2, 11, v30
    v_lshrrev_b32 v3, 2, v31
    v_lshl_add_u32 v2, v3, 5, v2
    v_and_b32 v3, 3, v31
    v_lshl_add_u32 v2, v3, 1, v2
    v_add_u32 v2, s14, v2
    s_add_u32 s14, s14, 32768
    v_lshl_add_u32 v29, v0, 4, s14
    ds_read_u16 v4, v2 offset:0
    ds_read_u16 v5, v2 offset:256
    ds_read_u16 v6, v2 offset:512
    ds_read_u16 v7, v2 offset:768
    ds_read_u16 v8, v2 offset:1024
    ds_read_u16 v9, v2 offset:1280
    ds_read_u16 v10, v2 offset:1536
    ds_read_u16 v11, v2 offset:1792
    s_waitcnt lgkmcnt(0)
    v_lshl_or_b32 v12, v5, 16, v4
    v_lshl_or_b32 v13, v7, 16, v6
    v_lshl_or_b32 v14, v9, 16, v8
    v_lshl_or_b32 v15, v11, 16, v10
    ds_write_b128 v29, v[12:15] offset:0
    ds_read_u16 v4, v2 offset:8
    ds_read_u16 v5, v2 offset:264
    ds_read_u16 v6, v2 offset:520
    ds_read_u16 v7, v2 offset:776
    ds_read_u16 v8, v2 offset:1032
    ds_read_u16 v9, v2 offset:1288
    ds_read_u16 v10, v2 offset:1544
    ds_read_u16 v11, v2 offset:1800
    s_waitcnt lgkmcnt(0)
    v_lshl_or_b32 v12, v5, 16, v4
    v_lshl_or_b32 v13, v7, 16, v6
    v_lshl_or_b32 v14, v9, 16, v8
    v_lshl_or_b32 v15, v11, 16, v10
    ds_write_b128 v29, v[12:15] offset:1024
    ds_read_u16 v4, v2 offset:16
    ds_read_u16 v5, v2 offset:272
    ds_read_u16 v6, v2 offset:528
    ds_read_u16 v7, v2 offset:784
    ds_read_u16 v8, v2 offset:1040
    ds_read_u16 v9, v2 offset:1296
    ds_read_u16 v10, v2 offset:1552
    ds_read_u16 v11, v2 offset:1808
    s_waitcnt lgkmcnt(0)
    v_lshl_or_b32 v12, v5, 16, v4
    v_lshl_or_b32 v13, v7, 16, v6
    v_lshl_or_b32 v14, v9, 16, v8
    v_lshl_or_b32 v15, v11, 16, v10
    ds_write_b128 v29, v[12:15] offset:2048
    ds_read_u16 v4, v2 offset:24
    ds_read_u16 v5, v2 offset:280
    ds_read_u16 v6, v2 offset:536
    ds_read_u16 v7, v2 offset:792
    ds_read_u16 v8, v2 offset:1048
    ds_read_u16 v9, v2 offset:1304
    ds_read_u16 v10, v2 offset:1560
    ds_read_u16 v11, v2 offset:1816
    s_waitcnt lgkmcnt(0)
    v_lshl_or_b32 v12, v5, 16, v4
    v_lshl_or_b32 v13, v7, 16, v6
    v_lshl_or_b32 v14, v9, 16, v8
    v_lshl_or_b32 v15, v11, 16, v10
    ds_write_b128 v29, v[12:15] offset:3072
    ds_read_u16 v4, v2 offset:128
    ds_read_u16 v5, v2 offset:384
    ds_read_u16 v6, v2 offset:640
    ds_read_u16 v7, v2 offset:896
    ds_read_u16 v8, v2 offset:1152
    ds_read_u16 v9, v2 offset:1408
    ds_read_u16 v10, v2 offset:1664
    ds_read_u16 v11, v2 offset:1920
    s_waitcnt lgkmcnt(0)
    v_lshl_or_b32 v12, v5, 16, v4
    v_lshl_or_b32 v13, v7, 16, v6
    v_lshl_or_b32 v14, v9, 16, v8
    v_lshl_or_b32 v15, v11, 16, v10
    ds_write_b128 v29, v[12:15] offset:4096
    ds_read_u16 v4, v2 offset:136
    ds_read_u16 v5, v2 offset:392
    ds_read_u16 v6, v2 offset:648
    ds_read_u16 v7, v2 offset:904
    ds_read_u16 v8, v2 offset:1160
    ds_read_u16 v9, v2 offset:1416
    ds_read_u16 v10, v2 offset:1672
    ds_read_u16 v11, v2 offset:1928
    s_waitcnt lgkmcnt(0)
    v_lshl_or_b32 v12, v5, 16, v4
    v_lshl_or_b32 v13, v7, 16, v6
    v_lshl_or_b32 v14, v9, 16, v8
    v_lshl_or_b32 v15, v11, 16, v10
    ds_write_b128 v29, v[12:15] offset:5120
    ds_read_u16 v4, v2 offset:144
    ds_read_u16 v5, v2 offset:400
    ds_read_u16 v6, v2 offset:656
    ds_read_u16 v7, v2 offset:912
    ds_read_u16 v8, v2 offset:1168
    ds_read_u16 v9, v2 offset:1424
    ds_read_u16 v10, v2 offset:1680
    ds_read_u16 v11, v2 offset:1936
    s_waitcnt lgkmcnt(0)
    v_lshl_or_b32 v12, v5, 16, v4
    v_lshl_or_b32 v13, v7, 16, v6
    v_lshl_or_b32 v14, v9, 16, v8
    v_lshl_or_b32 v15, v11, 16, v10
    ds_write_b128 v29, v[12:15] offset:6144
    ds_read_u16 v4, v2 offset:152
    ds_read_u16 v5, v2 offset:408
    ds_read_u16 v6, v2 offset:664
    ds_read_u16 v7, v2 offset:920
    ds_read_u16 v8, v2 offset:1176
    ds_read_u16 v9, v2 offset:1432
    ds_read_u16 v10, v2 offset:1688
    ds_read_u16 v11, v2 offset:1944
    s_waitcnt lgkmcnt(0)
    v_lshl_or_b32 v12, v5, 16, v4
    v_lshl_or_b32 v13, v7, 16, v6
    v_lshl_or_b32 v14, v9, 16, v8
    v_lshl_or_b32 v15, v11, 16, v10
    ds_write_b128 v29, v[12:15] offset:7168
    v_mov_b32 v4, 0
    s_mov_b32 s15, 131072
L_gu:
    ds_read_b32 v5, v4 offset:8
    s_waitcnt lgkmcnt(0)
    v_cmp_eq_u32 vcc, 4, v5
    s_cbranch_vccnz L_guok
    s_sleep 4
    s_sub_u32 s15, s15, 1
    s_cmp_lg_u32 s15, 0
    s_cbranch_scc1 L_gu
L_guok:
    v_bfe_u32 v2, v31, 1, 1
    v_lshlrev_b32 v2, 15, v2
    v_lshl_add_u32 v2, v30, 9, v2
    v_lshrrev_b32 v3, 2, v31
    v_lshl_add_u32 v2, v3, 2, v2
    v_and_b32 v3, 1, v31
    v_lshl_add_u32 v2, v3, 1, v2
    s_lshl_b32 s10, s7, 4
    s_add_u32 s10, s10, 32768
    v_add_u32 v2, s10, v2
    ds_read_u16 v4, v2 offset:0
    ds_read_u16 v5, v2 offset:64
    ds_read_u16 v6, v2 offset:128
    ds_read_u16 v7, v2 offset:192
    ds_read_u16 v8, v2 offset:256
    ds_read_u16 v9, v2 offset:320
    ds_read_u16 v10, v2 offset:384
    ds_read_u16 v11, v2 offset:448
    s_waitcnt lgkmcnt(0)
    v_lshl_or_b32 v32, v5, 16, v4
    v_lshl_or_b32 v33, v7, 16, v6
    v_lshl_or_b32 v34, v9, 16, v8
    v_lshl_or_b32 v35, v11, 16, v10
    ds_read_u16 v4, v2 offset:2048
    ds_read_u16 v5, v2 offset:2112
    ds_read_u16 v6, v2 offset:2176
    ds_read_u16 v7, v2 offset:2240
    ds_read_u16 v8, v2 offset:2304
    ds_read_u16 v9, v2 offset:2368
    ds_read_u16 v10, v2 offset:2432
    ds_read_u16 v11, v2 offset:2496
    s_waitcnt lgkmcnt(0)
    v_lshl_or_b32 v36, v5, 16, v4
    v_lshl_or_b32 v37, v7, 16, v6
    v_lshl_or_b32 v38, v9, 16, v8
    v_lshl_or_b32 v39, v11, 16, v10
    ds_read_u16 v4, v2 offset:4096
    ds_read_u16 v5, v2 offset:4160
    ds_read_u16 v6, v2 offset:4224
    ds_read_u16 v7, v2 offset:4288
    ds_read_u16 v8, v2 offset:4352
    ds_read_u16 v9, v2 offset:4416
    ds_read_u16 v10, v2 offset:4480
    ds_read_u16 v11, v2 offset:4544
    s_waitcnt lgkmcnt(0)
    v_lshl_or_b32 v40, v5, 16, v4
    v_lshl_or_b32 v41, v7, 16, v6
    v_lshl_or_b32 v42, v9, 16, v8
    v_lshl_or_b32 v43, v11, 16, v10
    ds_read_u16 v4, v2 offset:6144
    ds_read_u16 v5, v2 offset:6208
    ds_read_u16 v6, v2 offset:6272
    ds_read_u16 v7, v2 offset:6336
    ds_read_u16 v8, v2 offset:6400
    ds_read_u16 v9, v2 offset:6464
    ds_read_u16 v10, v2 offset:6528
    ds_read_u16 v11, v2 offset:6592
    s_waitcnt lgkmcnt(0)
    v_lshl_or_b32 v44, v5, 16, v4
    v_lshl_or_b32 v45, v7, 16, v6
    v_lshl_or_b32 v46, v9, 16, v8
    v_lshl_or_b32 v47, v11, 16, v10
    ds_read_u16 v4, v2 offset:8192
    ds_read_u16 v5, v2 offset:8256
    ds_read_u16 v6, v2 offset:8320
    ds_read_u16 v7, v2 offset:8384
    ds_read_u16 v8, v2 offset:8448
    ds_read_u16 v9, v2 offset:8512
    ds_read_u16 v10, v2 offset:8576
    ds_read_u16 v11, v2 offset:8640
    s_waitcnt lgkmcnt(0)
    v_lshl_or_b32 v48, v5, 16, v4
    v_lshl_or_b32 v49, v7, 16, v6
    v_lshl_or_b32 v50, v9, 16, v8
    v_lshl_or_b32 v51, v11, 16, v10
    ds_read_u16 v4, v2 offset:10240
    ds_read_u16 v5, v2 offset:10304
    ds_read_u16 v6, v2 offset:10368
    ds_read_u16 v7, v2 offset:10432
    ds_read_u16 v8, v2 offset:10496
    ds_read_u16 v9, v2 offset:10560
    ds_read_u16 v10, v2 offset:10624
    ds_read_u16 v11, v2 offset:10688
    s_waitcnt lgkmcnt(0)
    v_lshl_or_b32 v52, v5, 16, v4
    v_lshl_or_b32 v53, v7, 16, v6
    v_lshl_or_b32 v54, v9, 16, v8
    v_lshl_or_b32 v55, v11, 16, v10
    ds_read_u16 v4, v2 offset:12288
    ds_read_u16 v5, v2 offset:12352
    ds_read_u16 v6, v2 offset:12416
    ds_read_u16 v7, v2 offset:12480
    ds_read_u16 v8, v2 offset:12544
    ds_read_u16 v9, v2 offset:12608
    ds_read_u16 v10, v2 offset:12672
    ds_read_u16 v11, v2 offset:12736
    s_waitcnt lgkmcnt(0)
    v_lshl_or_b32 v56, v5, 16, v4
    v_lshl_or_b32 v57, v7, 16, v6
    v_lshl_or_b32 v58, v9, 16, v8
    v_lshl_or_b32 v59, v11, 16, v10
    ds_read_u16 v4, v2 offset:14336
    ds_read_u16 v5, v2 offset:14400
    ds_read_u16 v6, v2 offset:14464
    ds_read_u16 v7, v2 offset:14528
    ds_read_u16 v8, v2 offset:14592
    ds_read_u16 v9, v2 offset:14656
    ds_read_u16 v10, v2 offset:14720
    ds_read_u16 v11, v2 offset:14784
    s_waitcnt lgkmcnt(0)
    v_lshl_or_b32 v60, v5, 16, v4
    v_lshl_or_b32 v61, v7, 16, v6
    v_lshl_or_b32 v62, v9, 16, v8
    v_lshl_or_b32 v63, v11, 16, v10
    ds_read_u16 v4, v2 offset:16384
    ds_read_u16 v5, v2 offset:16448
    ds_read_u16 v6, v2 offset:16512
    ds_read_u16 v7, v2 offset:16576
    ds_read_u16 v8, v2 offset:16640
    ds_read_u16 v9, v2 offset:16704
    ds_read_u16 v10, v2 offset:16768
    ds_read_u16 v11, v2 offset:16832
    s_waitcnt lgkmcnt(0)
    v_lshl_or_b32 v64, v5, 16, v4
    v_lshl_or_b32 v65, v7, 16, v6
    v_lshl_or_b32 v66, v9, 16, v8
    v_lshl_or_b32 v67, v11, 16, v10
    ds_read_u16 v4, v2 offset:18432
    ds_read_u16 v5, v2 offset:18496
    ds_read_u16 v6, v2 offset:18560
    ds_read_u16 v7, v2 offset:18624
    ds_read_u16 v8, v2 offset:18688
    ds_read_u16 v9, v2 offset:18752
    ds_read_u16 v10, v2 offset:18816
    ds_read_u16 v11, v2 offset:18880
    s_waitcnt lgkmcnt(0)
    v_lshl_or_b32 v68, v5, 16, v4
    v_lshl_or_b32 v69, v7, 16, v6
    v_lshl_or_b32 v70, v9, 16, v8
    v_lshl_or_b32 v71, v11, 16, v10
    ds_read_u16 v4, v2 offset:20480
    ds_read_u16 v5, v2 offset:20544
    ds_read_u16 v6, v2 offset:20608
    ds_read_u16 v7, v2 offset:20672
    ds_read_u16 v8, v2 offset:20736
    ds_read_u16 v9, v2 offset:20800
    ds_read_u16 v10, v2 offset:20864
    ds_read_u16 v11, v2 offset:20928
    s_waitcnt lgkmcnt(0)
    v_lshl_or_b32 v72, v5, 16, v4
    v_lshl_or_b32 v73, v7, 16, v6
    v_lshl_or_b32 v74, v9, 16, v8
    v_lshl_or_b32 v75, v11, 16, v10
    ds_read_u16 v4, v2 offset:22528
    ds_read_u16 v5, v2 offset:22592
    ds_read_u16 v6, v2 offset:22656
    ds_read_u16 v7, v2 offset:22720
    ds_read_u16 v8, v2 offset:22784
    ds_read_u16 v9, v2 offset:22848
    ds_read_u16 v10, v2 offset:22912
    ds_read_u16 v11, v2 offset:22976
    s_waitcnt lgkmcnt(0)
    v_lshl_or_b32 v76, v5, 16, v4
    v_lshl_or_b32 v77, v7, 16, v6
    v_lshl_or_b32 v78, v9, 16, v8
    v_lshl_or_b32 v79, v11, 16, v10
    ds_read_u16 v4, v2 offset:24576
    ds_read_u16 v5, v2 offset:24640
    ds_read_u16 v6, v2 offset:24704
    ds_read_u16 v7, v2 offset:24768
    ds_read_u16 v8, v2 offset:24832
    ds_read_u16 v9, v2 offset:24896
    ds_read_u16 v10, v2 offset:24960
    ds_read_u16 v11, v2 offset:25024
    s_waitcnt lgkmcnt(0)
    v_lshl_or_b32 v80, v5, 16, v4
    v_lshl_or_b32 v81, v7, 16, v6
    v_lshl_or_b32 v82, v9, 16, v8
    v_lshl_or_b32 v83, v11, 16, v10
    ds_read_u16 v4, v2 offset:26624
    ds_read_u16 v5, v2 offset:26688
    ds_read_u16 v6, v2 offset:26752
    ds_read_u16 v7, v2 offset:26816
    ds_read_u16 v8, v2 offset:26880
    ds_read_u16 v9, v2 offset:26944
    ds_read_u16 v10, v2 offset:27008
    ds_read_u16 v11, v2 offset:27072
    s_waitcnt lgkmcnt(0)
    v_lshl_or_b32 v84, v5, 16, v4
    v_lshl_or_b32 v85, v7, 16, v6
    v_lshl_or_b32 v86, v9, 16, v8
    v_lshl_or_b32 v87, v11, 16, v10
    ds_read_u16 v4, v2 offset:28672
    ds_read_u16 v5, v2 offset:28736
    ds_read_u16 v6, v2 offset:28800
    ds_read_u16 v7, v2 offset:28864
    ds_read_u16 v8, v2 offset:28928
    ds_read_u16 v9, v2 offset:28992
    ds_read_u16 v10, v2 offset:29056
    ds_read_u16 v11, v2 offset:29120
    s_waitcnt lgkmcnt(0)
    v_lshl_or_b32 v88, v5, 16, v4
    v_lshl_or_b32 v89, v7, 16, v6
    v_lshl_or_b32 v90, v9, 16, v8
    v_lshl_or_b32 v91, v11, 16, v10
    ds_read_u16 v4, v2 offset:30720
    ds_read_u16 v5, v2 offset:30784
    ds_read_u16 v6, v2 offset:30848
    ds_read_u16 v7, v2 offset:30912
    ds_read_u16 v8, v2 offset:30976
    ds_read_u16 v9, v2 offset:31040
    ds_read_u16 v10, v2 offset:31104
    ds_read_u16 v11, v2 offset:31168
    s_waitcnt lgkmcnt(0)
    v_lshl_or_b32 v92, v5, 16, v4
    v_lshl_or_b32 v93, v7, 16, v6
    v_lshl_or_b32 v94, v9, 16, v8
    v_lshl_or_b32 v95, v11, 16, v10
    v_mov_b32 v4, 0
    v_mov_b32 v5, 1
    s_mov_b64 exec, 1
    ds_add_u32 v4, v5 offset:24
    s_mov_b64 exec, -1
    s_mov_b32 s48, s16
    s_mov_b32 s49, s17
    s_mov_b32 s50, 4096
    s_mov_b32 s51, 0x20000
    v_lshlrev_b32 v2, 5, v0
    v_lshlrev_b32 v3, 4, v0
    s_mul_i32 s10, s7, 12288
    s_add_u32 s10, s10, 8192
    s_add_u32 s11, s10, 4096
    s_lshl_b32 s14, s7, 10
    buffer_load_dwordx4 v[248:251], v3, s[48:51], s14 offen
    s_mov_b32 s15, 131072
L_sbpoll:
    buffer_load_dwordx4 v[224:227], v2, s[52:55], s10 offen sc1
    buffer_load_dwordx4 v[228:231], v2, s[52:55], s10 offen offset:16 sc1
    buffer_load_dwordx4 v[232:235], v2, s[52:55], s10 offen offset:2048 sc1
    buffer_load_dwordx4 v[236:239], v2, s[52:55], s10 offen offset:2064 sc1
    buffer_load_dwordx4 v[240:243], v2, s[52:55], s11 offen sc1
    buffer_load_dwordx4 v[244:247], v2, s[52:55], s11 offen offset:16 sc1
    s_waitcnt vmcnt(0)
    v_bitop3_b32 v12, v225, v227, s56 bitop3:0x7e
    v_bitop3_b32 v13, v229, v231, s56 bitop3:0x7e
    v_bitop3_b32 v14, v233, v235, s56 bitop3:0x7e
    v_bitop3_b32 v15, v237, v239, s56 bitop3:0x7e
    v_bitop3_b32 v16, v241, v243, s56 bitop3:0x7e
    v_bitop3_b32 v17, v245, v247, s56 bitop3:0x7e
    v_or3_b32 v12, v12, v13, v14
    v_or3_b32 v12, v12, v15, v16
    v_or_b32 v12, v12, v17
    v_cmp_ne_u32 vcc, 0, v12
    s_cbranch_vccz L_sbok
    s_sleep 16
    s_sub_u32 s15, s15, 1
    s_cmp_lg_u32 s15, 0
    s_cbranch_scc1 L_sbpoll
L_sbok:
    v_mov_b32 v4, 0
    s_mov_b32 s15, 131072
L_gudone:
    ds_read_b32 v5, v4 offset:24
    s_waitcnt lgkmcnt(0)
    v_cmp_eq_u32 vcc, 4, v5
    s_cbranch_vccnz L_gudoneok
    s_sleep 4
    s_sub_u32 s15, s15, 1
    s_cmp_lg_u32 s15, 0
    s_cbranch_scc1 L_gudone
L_gudoneok:
    s_mul_i32 s10, s7, 11520
    s_add_u32 s10, s10, 32768
    v_add_u32 v3, s10, v3
    v_mov_b32 v4, 0
    v_mov_b32 v5, 0
    v_mov_b32 v6, 0
    v_mov_b32 v7, 0
    ds_write_b128 v3, v[4:7] offset:0
    ds_write_b128 v3, v[4:7] offset:1024
    ds_write_b128 v3, v[4:7] offset:2048
    ds_write_b128 v3, v[4:7] offset:3072
    ds_write_b128 v3, v[4:7] offset:4096
    ds_write_b128 v3, v[4:7] offset:5120
    ds_write_b128 v3, v[4:7] offset:6144
    ds_write_b128 v3, v[4:7] offset:7168
    ds_write_b128 v3, v[4:7] offset:8192
    ds_write_b128 v3, v[4:7] offset:9216
    ds_write_b128 v3, v[4:7] offset:10240
    s_mov_b64 exec, 0xffff
    ds_write_b128 v3, v[4:7] offset:11264
    s_mov_b64 exec, -1
    v_lshl_add_u32 v2, v30, 4, v2
    v_add_u32 v2, s10, v2
    v_lshlrev_b32 v12, 16, v224
    v_and_b32 v13, 0xffff0000, v224
    v_lshlrev_b32 v14, 16, v226
    v_and_b32 v15, 0xffff0000, v226
    v_lshlrev_b32 v16, 16, v228
    v_and_b32 v17, 0xffff0000, v228
    v_lshlrev_b32 v18, 16, v230
    v_and_b32 v19, 0xffff0000, v230
    ds_write_b128 v2, v[12:15] offset:0
    ds_write_b128 v2, v[16:19] offset:16
    s_waitcnt lgkmcnt(0)
    v_lshlrev_b32 v12, 16, v248
    v_and_b32 v13, 0xffff0000, v248
    v_lshlrev_b32 v14, 16, v249
    v_and_b32 v15, 0xffff0000, v249
    v_lshlrev_b32 v16, 16, v250
    v_and_b32 v17, 0xffff0000, v250
    v_lshlrev_b32 v18, 16, v251
    v_and_b32 v19, 0xffff0000, v251
    ds_write_b128 v2, v[12:15] offset:2304
    ds_write_b128 v2, v[16:19] offset:2320
    s_waitcnt lgkmcnt(0)
    v_mov_b32 v12, 1.0
    v_mov_b32 v13, 1.0
    v_mov_b32 v14, 1.0
    v_mov_b32 v15, 1.0
    v_mov_b32 v16, 1.0
    v_mov_b32 v17, 1.0
    v_mov_b32 v18, 1.0
    v_mov_b32 v19, 1.0
    ds_write_b128 v2, v[12:15] offset:4608
    ds_write_b128 v2, v[16:19] offset:4624
    s_waitcnt lgkmcnt(0)
    v_lshlrev_b32 v12, 16, v240
    v_and_b32 v13, 0xffff0000, v240
    v_lshlrev_b32 v14, 16, v242
    v_and_b32 v15, 0xffff0000, v242
    v_lshlrev_b32 v16, 16, v244
    v_and_b32 v17, 0xffff0000, v244
    v_lshlrev_b32 v18, 16, v246
    v_and_b32 v19, 0xffff0000, v246
    ds_write_b128 v2, v[12:15] offset:6912
    ds_write_b128 v2, v[16:19] offset:6928
    s_waitcnt lgkmcnt(0)
    v_lshlrev_b32 v12, 16, v232
    v_and_b32 v13, 0xffff0000, v232
    v_lshlrev_b32 v14, 16, v234
    v_and_b32 v15, 0xffff0000, v234
    v_lshlrev_b32 v16, 16, v236
    v_and_b32 v17, 0xffff0000, v236
    v_lshlrev_b32 v18, 16, v238
    v_and_b32 v19, 0xffff0000, v238
    ds_write_b128 v2, v[12:15] offset:9216
    ds_write_b128 v2, v[16:19] offset:9232
    s_waitcnt lgkmcnt(0)
    v_mov_b32 v4, 0
    v_mov_b32 v5, 1
    s_mov_b64 exec, 1
    ds_add_u32 v4, v5 offset:28
    s_mov_b64 exec, -1
L_noffn:
    v_and_b32 v2, 7, v31
    v_mul_u32_u24 v2, 272, v2
    v_lshl_add_u32 v2, v30, 4, v2
    s_mul_i32 s11, s7, 640
    s_add_u32 s11, s11, 23424
    v_mov_b32 v4, 0
    v_mov_b32 v5, 0
    v_mov_b32 v6, 0
    v_mov_b32 v7, 0
    v_mov_b32 v8, 1.0
    v_mov_b32 v9, s11
    ds_write_b128 v9, v[4:7] offset:512
    ds_write_b32 v9, v8 offset:528
    v_lshlrev_b32 v3, 5, v31
    v_lshl_add_u32 v3, v30, 4, v3
    v_add_u32 v3, s11, v3
    v_lshrrev_b32 v4, 2, v0
    v_sub_u32 v4, v0, v4
    v_lshlrev_b32 v4, 2, v4
    v_and_b32 v5, 3, v0
    v_cmp_eq_u32 vcc, 3, v5
    v_mov_b32 v6, 528
    s_mov_b64 s[64:65], vcc
    v_cndmask_b32 v1, v4, v6, vcc
    v_add_u32 v1, s11, v1
    s_mul_i32 s10, s5, 2816
    s_mul_i32 s11, s7, 704
    s_add_u32 s10, s10, s11
    s_add_u32 s10, s10, 131072
    v_mov_b32 v28, 0xff
    v_lshlrev_b32 v10, 7, v0
    v_mov_b32 v11, 1
    s_mul_i32 s15, s5, 6144
    s_add_u32 s15, s15, 167936
    s_waitcnt vmcnt(0) lgkmcnt(0)
    s_mov_b32 s94, s7
    s_setprio 3
    s_barrier
L_t0calc:
    ds_read_b128 v[12:15], v2 offset:25984
    ds_read_b128 v[16:19], v2 offset:26048
    ds_read_b128 v[20:23], v2 offset:26112
    ds_read_b128 v[24:27], v2 offset:26176
    s_waitcnt lgkmcnt(3)
    v_mfma_f32_16x16x32_bf16 v[224:227], v[12:15], v[96:99], 0
    v_mfma_f32_16x16x32_bf16 v[228:231], v[12:15], v[100:103], 0
    v_mfma_f32_16x16x32_bf16 v[232:235], v[12:15], v[104:107], 0
    v_mfma_f32_16x16x32_bf16 v[236:239], v[12:15], v[108:111], 0
    v_mfma_f32_16x16x32_bf16 v[240:243], v[12:15], v[112:115], 0
    v_mfma_f32_16x16x32_bf16 v[244:247], v[12:15], v[116:119], 0
    v_mfma_f32_16x16x32_bf16 v[248:251], v[12:15], v[120:123], 0
    v_mfma_f32_16x16x32_bf16 v[252:255], v[12:15], v[124:127], 0
    s_waitcnt lgkmcnt(2)
    v_mfma_f32_16x16x32_bf16 v[224:227], v[16:19], v[128:131], v[224:227]
    v_mfma_f32_16x16x32_bf16 v[228:231], v[16:19], v[132:135], v[228:231]
    v_mfma_f32_16x16x32_bf16 v[232:235], v[16:19], v[136:139], v[232:235]
    v_mfma_f32_16x16x32_bf16 v[236:239], v[16:19], v[140:143], v[236:239]
    v_mfma_f32_16x16x32_bf16 v[240:243], v[16:19], v[144:147], v[240:243]
    v_mfma_f32_16x16x32_bf16 v[244:247], v[16:19], v[148:151], v[244:247]
    v_mfma_f32_16x16x32_bf16 v[248:251], v[16:19], v[152:155], v[248:251]
    v_mfma_f32_16x16x32_bf16 v[252:255], v[16:19], v[156:159], v[252:255]
    s_waitcnt lgkmcnt(1)
    v_mfma_f32_16x16x32_bf16 v[224:227], v[20:23], v[160:163], v[224:227]
    v_mfma_f32_16x16x32_bf16 v[228:231], v[20:23], v[164:167], v[228:231]
    v_mfma_f32_16x16x32_bf16 v[232:235], v[20:23], v[168:171], v[232:235]
    v_mfma_f32_16x16x32_bf16 v[236:239], v[20:23], v[172:175], v[236:239]
    v_mfma_f32_16x16x32_bf16 v[240:243], v[20:23], v[176:179], v[240:243]
    v_mfma_f32_16x16x32_bf16 v[244:247], v[20:23], v[180:183], v[244:247]
    v_mfma_f32_16x16x32_bf16 v[248:251], v[20:23], v[184:187], v[248:251]
    v_mfma_f32_16x16x32_bf16 v[252:255], v[20:23], v[188:191], v[252:255]
    s_waitcnt lgkmcnt(0)
    v_mfma_f32_16x16x32_bf16 v[224:227], v[24:27], v[192:195], v[224:227]
    v_mfma_f32_16x16x32_bf16 v[228:231], v[24:27], v[196:199], v[228:231]
    s_cmp_lg_u32 s94, 3
    s_cbranch_scc1 L_n1
    s_mov_b64 exec, 0xff
    buffer_atomic_add v11, v10, s[52:55], s15 offen sc1
    s_mov_b64 exec, -1
L_n1:
    v_mfma_f32_16x16x32_bf16 v[232:235], v[24:27], v[200:203], v[232:235]
    v_mfma_f32_16x16x32_bf16 v[236:239], v[24:27], v[204:207], v[236:239]
    v_mfma_f32_16x16x32_bf16 v[240:243], v[24:27], v[208:211], v[240:243]
    v_mfma_f32_16x16x32_bf16 v[244:247], v[24:27], v[212:215], v[244:247]
    v_mfma_f32_16x16x32_bf16 v[248:251], v[24:27], v[216:219], v[248:251]
    v_mfma_f32_16x16x32_bf16 v[252:255], v[24:27], v[220:223], v[252:255]
    v_pk_add_f32 v[224:225], v[224:225], v[226:227]
    v_add_f32 v4, v224, v225
    v_pk_add_f32 v[228:229], v[228:229], v[230:231]
    v_add_f32 v5, v228, v229
    v_pk_add_f32 v[232:233], v[232:233], v[234:235]
    v_add_f32 v6, v232, v233
    v_pk_add_f32 v[236:237], v[236:237], v[238:239]
    v_add_f32 v7, v236, v237
    v_pk_add_f32 v[240:241], v[240:241], v[242:243]
    v_add_f32 v8, v240, v241
    v_pk_add_f32 v[244:245], v[244:245], v[246:247]
    v_add_f32 v9, v244, v245
    v_pk_add_f32 v[248:249], v[248:249], v[250:251]
    v_add_f32 v10, v248, v249
    v_pk_add_f32 v[252:253], v[252:253], v[254:255]
    v_add_f32 v11, v252, v253
    v_permlane16_swap_b32 v4, v8
    v_permlane16_swap_b32 v5, v9
    v_permlane16_swap_b32 v6, v10
    v_permlane16_swap_b32 v7, v11
    v_add_f32 v4, v4, v8
    v_add_f32 v5, v5, v9
    v_add_f32 v6, v6, v10
    v_add_f32 v7, v7, v11
    s_mov_b32 exec_hi, 0
    ds_write_b128 v3, v[4:7]
    s_mov_b64 exec, -1
    ds_read_b32 v8, v1
    ds_read_b32 v9, v1 offset:192
    ds_read_b32 v10, v1 offset:384
    v_lshlrev_b32 v11, 2, v0
    s_waitcnt lgkmcnt(2)
    buffer_atomic_add_f32 v8, v11, s[52:55], s10 offen sc1
    s_waitcnt lgkmcnt(0)
    v_cndmask_b32 v9, v9, v8, s[64:65]
    v_cndmask_b32 v10, v10, v8, s[64:65]
    buffer_atomic_add_f32 v9, v11, s[52:55], s10 offen offset:256 sc1
    s_mov_b32 exec_hi, 0xffff
    buffer_atomic_add_f32 v10, v11, s[52:55], s10 offen offset:512 sc1
    s_mov_b64 exec, -1
    s_cmp_eq_u32 s12, 0
    s_cbranch_scc1 L_done2
    ds_read_b128 v[160:163], v29 offset:0
    ds_read_b128 v[164:167], v29 offset:1024
    ds_read_b128 v[168:171], v29 offset:2048
    ds_read_b128 v[172:175], v29 offset:3072
    ds_read_b128 v[176:179], v29 offset:4096
    ds_read_b128 v[180:183], v29 offset:5120
    ds_read_b128 v[184:187], v29 offset:6144
    ds_read_b128 v[188:191], v29 offset:7168
    v_mov_b32 v192, 0
    v_mov_b32 v193, 0
    v_mov_b32 v194, 0
    v_mov_b32 v195, 0
    v_mov_b32 v196, 0
    v_mov_b32 v197, 0
    v_mov_b32 v198, 0
    v_mov_b32 v199, 0
    v_mov_b32 v200, 0
    v_mov_b32 v201, 0
    v_mov_b32 v202, 0
    v_mov_b32 v203, 0
    v_mov_b32 v204, 0
    v_mov_b32 v205, 0
    v_mov_b32 v206, 0
    v_mov_b32 v207, 0
    v_and_b32 v24, 3, v31
    v_mul_u32_u24 v1, 1232, v24
    v_lshl_add_u32 v1, v30, 4, v1
    s_lshl_b32 s11, s7, 6
    v_lshl_add_u32 v25, v31, 4, s11
    v_lshl_add_u32 v25, v30, 2, v25
    v_lshlrev_b32 v26, 6, v30
    v_lshrrev_b32 v24, 2, v31
    v_lshl_add_u32 v26, v24, 4, v26
    v_lshlrev_b32 v27, 4, v0
    s_mul_i32 s14, s13, 8192
    s_lshl_b32 s11, s7, 11
    s_add_u32 s14, s14, s11
    s_add_u32 s14, s14, 786432
    s_mov_b32 s59, 0xbdd2d3e8
    v_mov_b32 v23, 0xc0135761
    v_mul_u32_u24 v21, 5504, v0
    v_mov_b32 v22, s56
    s_lshr_b32 s69, s56, 8
    s_lshr_b32 s70, s56, 16
    s_lshr_b32 s71, s56, 24
    s_lshl_b32 s10, s13, 7
    s_add_u32 s10, s10, 147456
    s_waitcnt lgkmcnt(0)
    s_barrier
L_t2calc:
    ds_read_b128 v[96:99], v1 offset:10880
    ds_read_b128 v[100:103], v1 offset:10944
    ds_read_b128 v[104:107], v1 offset:11008
    ds_read_b128 v[108:111], v1 offset:11072
    ds_read_b128 v[112:115], v1 offset:11152
    ds_read_b128 v[116:119], v1 offset:11216
    ds_read_b128 v[120:123], v1 offset:11280
    ds_read_b128 v[124:127], v1 offset:11344
    ds_read_b128 v[128:131], v1 offset:11424
    ds_read_b128 v[132:135], v1 offset:11488
    ds_read_b128 v[136:139], v1 offset:11552
    ds_read_b128 v[140:143], v1 offset:11616
    ds_read_b128 v[144:147], v1 offset:11696
    ds_read_b128 v[148:151], v1 offset:11760
    ds_read_b128 v[152:155], v1 offset:11824
    s_waitcnt lgkmcnt(14)
    v_mfma_f32_16x16x32_bf16 v[4:7], v[32:35], v[96:99], 0
    ds_read_b128 v[156:159], v1 offset:11888
    s_waitcnt lgkmcnt(14)
    v_mfma_f32_16x16x32_bf16 v[8:11], v[36:39], v[100:103], 0
    s_waitcnt lgkmcnt(13)
    v_mfma_f32_16x16x32_bf16 v[4:7], v[40:43], v[104:107], v[4:7]
    s_waitcnt lgkmcnt(12)
    v_mfma_f32_16x16x32_bf16 v[8:11], v[44:47], v[108:111], v[8:11]
    s_waitcnt lgkmcnt(11)
    v_mfma_f32_16x16x32_bf16 v[4:7], v[48:51], v[112:115], v[4:7]
    s_waitcnt lgkmcnt(10)
    v_mfma_f32_16x16x32_bf16 v[8:11], v[52:55], v[116:119], v[8:11]
    s_waitcnt lgkmcnt(9)
    v_mfma_f32_16x16x32_bf16 v[4:7], v[56:59], v[120:123], v[4:7]
    s_waitcnt lgkmcnt(8)
    v_mfma_f32_16x16x32_bf16 v[8:11], v[60:63], v[124:127], v[8:11]
    s_waitcnt lgkmcnt(7)
    v_mfma_f32_16x16x32_bf16 v[4:7], v[64:67], v[128:131], v[4:7]
    s_waitcnt lgkmcnt(6)
    v_mfma_f32_16x16x32_bf16 v[8:11], v[68:71], v[132:135], v[8:11]
    s_waitcnt lgkmcnt(5)
    v_mfma_f32_16x16x32_bf16 v[4:7], v[72:75], v[136:139], v[4:7]
    s_waitcnt lgkmcnt(4)
    v_mfma_f32_16x16x32_bf16 v[8:11], v[76:79], v[140:143], v[8:11]
    s_waitcnt lgkmcnt(3)
    v_mfma_f32_16x16x32_bf16 v[4:7], v[80:83], v[144:147], v[4:7]
    s_waitcnt lgkmcnt(2)
    v_mfma_f32_16x16x32_bf16 v[8:11], v[84:87], v[148:151], v[8:11]
    s_waitcnt lgkmcnt(1)
    v_mfma_f32_16x16x32_bf16 v[4:7], v[88:91], v[152:155], v[4:7]
    s_waitcnt lgkmcnt(0)
    v_mfma_f32_16x16x32_bf16 v[8:11], v[92:95], v[156:159], v[8:11]
    s_nop 7
    v_add_f32 v4, v4, v8
    v_add_f32 v5, v5, v9
    v_add_f32 v6, v6, v10
    v_add_f32 v7, v7, v11
    v_cvt_pk_bf16_f32 v12, v4, v5
    v_cvt_pk_bf16_f32 v13, v6, v7
    v_lshlrev_b32 v4, 16, v12
    v_and_b32 v5, 0xffff0000, v12
    v_lshlrev_b32 v6, 16, v13
    v_and_b32 v7, 0xffff0000, v13
    v_mul_f32 v8, v4, v4
    v_mul_f32 v9, v5, v5
    v_fma_f32 v8, v8, s59, v23
    v_fma_f32 v9, v9, s59, v23
    v_mul_f32 v8, v8, v4
    v_mul_f32 v9, v9, v5
    v_exp_f32 v8, v8
    v_exp_f32 v9, v9
    v_add_f32 v8, 1.0, v8
    v_add_f32 v9, 1.0, v9
    v_rcp_f32 v8, v8
    v_rcp_f32 v9, v9
    v_mul_f32 v8, v8, v4
    v_mul_f32 v9, v9, v5
    v_cvt_pk_bf16_f32 v12, v8, v9
    v_lshlrev_b32 v8, 16, v12
    v_and_b32 v9, 0xffff0000, v12
    v_mul_f32 v8, v8, v6
    v_mul_f32 v9, v9, v7
    v_cvt_pk_bf16_f32 v12, v8, v9
    s_mov_b32 exec_lo, 0xf000f
    s_mov_b32 exec_hi, 0xf000f
    ds_write_b32 v25, v12 offset:15808
    s_mov_b32 exec_lo, 0x11111111
    s_mov_b32 exec_hi, 0x11111111
    s_waitcnt lgkmcnt(0)
    s_barrier
L_t2nob:
    ds_read_b128 v[192:195], v26 offset:15808
    s_mov_b32 exec_lo, 0x22222222
    s_mov_b32 exec_hi, 0x22222222
    ds_read_b128 v[196:199], v26 offset:15808
    s_mov_b32 exec_lo, 0x44444444
    s_mov_b32 exec_hi, 0x44444444
    ds_read_b128 v[200:203], v26 offset:15808
    s_mov_b32 exec_lo, 0x88888888
    s_mov_b32 exec_hi, 0x88888888
    ds_read_b128 v[204:207], v26 offset:15808
    s_mov_b64 exec, -1
    s_waitcnt lgkmcnt(3)
    v_mfma_f32_16x16x32_bf16 v[4:7], v[160:163], v[192:195], 0
    v_mfma_f32_16x16x32_bf16 v[8:11], v[176:179], v[192:195], 0
    s_waitcnt lgkmcnt(2)
    v_mfma_f32_16x16x32_bf16 v[4:7], v[164:167], v[196:199], v[4:7]
    v_mfma_f32_16x16x32_bf16 v[8:11], v[180:183], v[196:199], v[8:11]
    s_waitcnt lgkmcnt(1)
    v_mfma_f32_16x16x32_bf16 v[4:7], v[168:171], v[200:203], v[4:7]
    v_mfma_f32_16x16x32_bf16 v[8:11], v[184:187], v[200:203], v[8:11]
    s_waitcnt lgkmcnt(0)
    v_mfma_f32_16x16x32_bf16 v[4:7], v[172:175], v[204:207], v[4:7]
    v_mfma_f32_16x16x32_bf16 v[8:11], v[188:191], v[204:207], v[8:11]
    s_nop 6
    v_bfi_b32 v4, v28, s56, v4
    v_bfi_b32 v5, v28, s69, v5
    v_bfi_b32 v6, v28, s70, v6
    v_bfi_b32 v7, v28, s71, v7
    s_cmp_lg_u32 s7, 0
    s_cbranch_scc1 L_nohint2
    s_mov_b64 s[64:65], exec
    s_mov_b64 exec, 7
    buffer_store_dword v22, v21, s[52:55], s10 offen sc1
    s_mov_b64 exec, s[64:65]
L_nohint2:
    buffer_store_dwordx4 v[4:7], v27, s[52:55], s14 offen sc1
    v_bfi_b32 v8, v28, s56, v8
    v_bfi_b32 v9, v28, s69, v9
    v_bfi_b32 v10, v28, s70, v10
    v_bfi_b32 v11, v28, s71, v11
    buffer_store_dwordx4 v[8:11], v27, s[52:55], s14 offen offset:1024 sc1
    s_add_u32 s10, s13, s7
    s_cmp_lg_u32 s10, 0
    s_cbranch_scc1 L_noepoch
    s_mov_b64 exec, 1
    v_mov_b32 v2, 0
    v_mov_b32 v3, s56
    buffer_store_dword v3, v2, s[52:55], 0 offen sc1
L_noepoch:
L_done2:
    s_endpgm
L_exit:
    s_endpgm
.section .rodata,"a"
.p2align 6
.amdhsa_kernel adaLN_cond__gqa_block_cached__glu_gated_geglu__decode_kernel
  .amdhsa_next_free_vgpr 256
  .amdhsa_next_free_sgpr 102
  .amdhsa_accum_offset 256
  .amdhsa_group_segment_fixed_size 0
  .amdhsa_kernarg_size 112
  .amdhsa_user_sgpr_count 2
  .amdhsa_user_sgpr_kernarg_segment_ptr 1
  .amdhsa_system_sgpr_workgroup_id_x 1
  .amdhsa_float_denorm_mode_32 3
.end_amdhsa_kernel
```
